```python
import torch

def _softmax(x, axis=-1):
    return torch.softmax(x, dim=axis)
def _gelu(x):
    return torch.nn.functional.gelu(x, approximate="tanh")
def _silu(x):
    return torch.nn.functional.silu(x)
def _sigmoid(x):
    return torch.sigmoid(x)
def _layernorm(x, axis=-1, eps=1e-5):
    m = x.mean(dim=axis, keepdim=True)
    v = x.var(dim=axis, keepdim=True, unbiased=False)
    return (x - m) / torch.sqrt(v + eps)
def _scatter_add(tgt, idx, src, axis=0):
    return tgt.clone().index_add_(axis, idx, src)
def _segment_sum(src, seg, n):
    out = torch.zeros((n,) + src.shape[1:], dtype=src.dtype)
    return out.index_add_(0, seg, src)
def _pad(x, pw):
    flat = tuple(v for pair in reversed(pw) for v in pair)
    return torch.nn.functional.pad(x, flat)

kernel_name = 'gated_mix__sliding_block_cached__glu_gated_glu__decode'

def setup_inputs():

    _w = (lambda a: (lambda t: t.to(torch.bfloat16) if t.is_floating_point() else t)(torch.as_tensor(a)))
    def _A_setup():
        B, Sq, D = 2, 1, 1024
        Hq, Hkv, Sk, Dh = 32, 4, 32768, 128
        assert Hq % Hkv == 0, (Hq, Hkv)
        return {
            "x": _w((lambda *s: torch.randn(*s, dtype=torch.bfloat16) * 0.05)(B, Sq, D)),
            "k_cache": _w((lambda *s: torch.randn(*s, dtype=torch.bfloat16) * 6.4)(B, Hkv, Sk, Dh)),
            "v_cache": _w((lambda *s: torch.randn(*s, dtype=torch.bfloat16) * 1.6)(B, Hkv, Sk, Dh)),
            "wq": _w((lambda *s: torch.randn(*s, dtype=torch.bfloat16) * 6.4)(D, Hq * Dh) * (D ** -0.5)),
            "wo": _w((lambda *s: torch.randn(*s, dtype=torch.bfloat16) * 1.6)(Hq * Dh, D) * ((Hq * Dh) ** -0.5)),
        }
    _A_in = _A_setup()

    def _B_setup():
        B, S, D, F = 2, 1, 1024, 3584
        return {
            "x": _w((lambda *s: torch.randn(*s, dtype=torch.bfloat16) * 0.05)(B, S, D)),
            "w_gate": _w((lambda *s: torch.randn(*s, dtype=torch.bfloat16) * 0.8)(D, F)),
            "w_up": _w((lambda *s: torch.randn(*s, dtype=torch.bfloat16) * 0.05)(D, F)),
            "w_down": _w((lambda *s: torch.randn(*s, dtype=torch.bfloat16) * 0.05)(F, D)),
        }
    _B_in = _B_setup()

    return {
        "A_x": _A_in["x"],
        "A_k_cache": _A_in["k_cache"],
        "A_v_cache": _A_in["v_cache"],
        "A_wq": _A_in["wq"],
        "A_wo": _A_in["wo"],
        "B_x": _B_in["x"],
        "B_w_gate": _B_in["w_gate"],
        "B_w_up": _B_in["w_up"],
        "B_w_down": _B_in["w_down"],
        "gate_w": _w((lambda *s: torch.randn(*s, dtype=torch.bfloat16) * 0.05)(1024) * 16.0),
    }

def reference(A_x, A_k_cache, A_v_cache, A_wq, A_wo, B_x, B_w_gate, B_w_up, B_w_down, gate_w):
    def _A_ref(x, k_cache, v_cache, wq, wo):
        B, Sq, D = x.shape
        Hq, Dh = 32, 128
        Hkv, Sk = k_cache.shape[1], k_cache.shape[2]
        W = min(4096, max(256, Sk // 4))
        rep = Hq // Hkv
        q = (lambda x, *d: x.permute(*d))((x @ wq).reshape(B, Sq, Hq, Dh), 0, 2, 1, 3)
        k = (lambda x, n, axis: torch.repeat_interleave(x, n, dim=axis))(k_cache[:, :, Sk - W:, :], rep, axis=1)
        v = (lambda x, n, axis: torch.repeat_interleave(x, n, dim=axis))(v_cache[:, :, Sk - W:, :], rep, axis=1)
        scores = torch.einsum("bhqd,bhkd->bhqk", q, k) * (Dh ** -0.5)
        p = _softmax(scores, axis=-1)
        o = torch.einsum("bhqk,bhkd->bhqd", p, v)
        return (lambda x, *d: x.permute(*d))(o, 0, 2, 1, 3).reshape(B, Sq, Hq * Dh) @ wo

    def _B_ref(x, w_gate, w_up, w_down):
        g = torch.einsum("bsd,df->bsf", x, w_gate)
        u = torch.einsum("bsd,df->bsf", x, w_up)
        h = _sigmoid(g) * u
        return torch.einsum("bsf,fd->bsd", h, w_down)

    x = A_x
    g = _sigmoid((x * gate_w).sum(-1, keepdims=True))
    a = _A_ref(x, A_k_cache, A_v_cache, A_wq, A_wo)
    b = _B_ref(x, B_w_gate, B_w_up, B_w_down)
    return g * a + (1 - g) * b
```

```asm
; @launch grid=(256,1,1) block=(512,1,1) lds=92160
.amdgcn_target "amdgcn-amd-amdhsa--gfx950"
.text
.globl gated_mix__sliding_block_cached__glu_gated_glu__decode_kernel
.p2align 8
.type gated_mix__sliding_block_cached__glu_gated_glu__decode_kernel,@function
gated_mix__sliding_block_cached__glu_gated_glu__decode_kernel:
    s_cmp_ge_u32 s2, 256
    s_cbranch_scc1 L_exit
    s_load_dwordx2 s[16:17], s[0:1], 24
    s_load_dwordx2 s[4:5], s[0:1], 0
    v_lshrrev_b32 v4, 6, v0
    v_mov_b32 v6, 0
    v_mov_b32 v7, 0
    v_lshlrev_b32 v8, 3, v0
    v_readfirstlane_b32 s3, v4
    ds_write_b64 v8, v[6:7]
    v_and_b32 v5, 63, v0
    s_and_b32 s67, s2, 7
    s_lshr_b32 s63, s2, 5
    s_bfe_u32 s68, s2, 0x20003
    s_lshl3_add_u32 s69, s67, s63
    s_mov_b32 s6, 4096
    s_mov_b32 s7, 0x20000
    s_cmp_lt_u32 s3, 4
    s_cbranch_scc1 L_A
    s_getpc_b64 s[44:45]
L_pc:
    s_mul_i32 s64, s3, 2816
    s_sub_u32 s64, s64, L_pc-gated_mix__sliding_block_cached__glu_gated_glu__decode_kernel+11264
    s_ashr_i32 s65, s64, 31
    s_add_u32 s44, s44, s64
    s_addc_u32 s45, s45, s65
    v_min_u32 v8, 21, v5
    v_lshlrev_b32 v8, 7, v8
    v_mov_b32 v9, s45
    v_add_co_u32 v8, vcc, s44, v8
    s_nop 1
    v_addc_co_u32 v9, vcc, 0, v9, vcc
    global_load_dword v250, v[8:9], off
    s_load_dwordx2 s[40:41], s[0:1], 96
    s_load_dwordx2 s[32:33], s[0:1], 72
    s_load_dwordx2 s[36:37], s[0:1], 80
    s_waitcnt lgkmcnt(0)
    s_barrier
    s_branch L_B
L_A:
    s_setprio 2
    s_mov_b32 s18, 8388608
    s_mov_b32 s19, 0x20000
    v_lshrrev_b32 v17, 3, v0
    v_and_b32 v18, 7, v0
    v_lshlrev_b32 v18, 4, v18
    v_lshl_or_b32 v6, v17, 16, v18
    v_bfe_u32 v19, v0, 3, 1
    v_lshlrev_b32 v11, 11, v19
    v_lshrrev_b32 v19, 4, v0
    v_lshl_or_b32 v11, v19, 5, v11
    v_and_b32 v19, 4, v0
    v_lshl_or_b32 v11, v19, 2, v11
    s_xor_b32 s65, s67, 2
    s_add_u32 s64, s65, 8
    s_cmp_eq_u32 s63, 3
    s_cselect_b32 s64, s64, s69
    s_cmp_eq_u32 s65, 3
    s_mul_i32 s65, s63, 8
    s_bitset1_b32 s65, 0
    s_bitset1_b32 s65, 1
    s_cselect_b32 s64, s65, s64
    s_and_b32 s65, s2, 8
    s_xor_b32 s64, s64, s65
    s_lshl_b32 s64, s64, 7
    s_lshl_b32 s44, s68, 21
    s_add_u32 s44, s44, s64
    s_lshl_b32 s65, s68, 9
    s_waitcnt lgkmcnt(0)
    buffer_load_dwordx4 v[28:31], v11, s[4:7], s65 offen
    buffer_load_dwordx4 v[128:131], v6, s[16:19], s44 offen nt
    s_addk_i32 s44, 8192
    buffer_load_dwordx4 v[132:135], v6, s[16:19], s44 offen nt
    s_addk_i32 s44, 8192
    buffer_load_dwordx4 v[136:139], v6, s[16:19], s44 offen nt
    s_addk_i32 s44, 8192
    buffer_load_dwordx4 v[140:143], v6, s[16:19], s44 offen nt
    s_addk_i32 s44, 8192
    buffer_load_dwordx4 v[144:147], v6, s[16:19], s44 offen nt
    s_addk_i32 s44, 8192
    s_bfe_u32 s64, s64, 0x30007
    s_lshr_b32 s36, 8, s64
    s_bitcmp1_b32 s36, 0
    s_cbranch_scc0 L_shallow
    buffer_load_dwordx4 v[148:151], v6, s[16:19], s44 offen nt
    s_addk_i32 s44, 8192
    buffer_load_dwordx4 v[152:155], v6, s[16:19], s44 offen nt
    s_addk_i32 s44, 8192
    buffer_load_dwordx4 v[156:159], v6, s[16:19], s44 offen nt
L_shallow:
    s_load_dwordx2 s[8:9], s[0:1], 8
    s_load_dwordx2 s[12:13], s[0:1], 16
    s_load_dwordx2 s[40:41], s[0:1], 96
    s_load_dwordx2 s[20:21], s[0:1], 32
    s_load_dwordx2 s[28:29], s[0:1], 64
    s_load_dwordx4 s[48:51], s[0:1], 48
    s_barrier
    s_mov_b32 s10, 67108864
    s_mov_b32 s11, 0x20000
    s_mov_b32 s14, 67108864
    s_mov_b32 s15, 0x20000
    s_mov_b32 s22, 8388608
    s_mov_b32 s23, 0x20000
    s_mov_b32 s30, 7340032
    s_mov_b32 s31, 0x20000
    s_mov_b32 s26, 7340032
    s_mov_b32 s27, 0x20000
    s_mov_b32 s34, 7340032
    s_mov_b32 s35, 0x20000
    s_mov_b32 s42, 6291456
    s_mov_b32 s43, 0x20000
    s_mov_b32 s60, 200000
    s_mov_b32 s62, 0xffffff00
    v_lshlrev_b32 v1, 2, v5
    v_mov_b32 v3, 1
    v_and_b32 v19, 3, v0
    v_mov_b32 v20, 0x0c0c0c0c
    v_mov_b32 v2, 0xc0c0100
    v_cmp_eq_u32 vcc, 0, v19
    s_nop 1
    v_cndmask_b32 v20, v20, v2, vcc
    v_mov_b32 v2, 0x1000c0c
    v_cmp_eq_u32 vcc, 1, v19
    s_nop 1
    v_cndmask_b32 v20, v20, v2, vcc
    v_mov_b32 v21, 0x0c0c0c0c
    v_mov_b32 v2, 0xc0c0302
    v_cmp_eq_u32 vcc, 0, v19
    s_nop 1
    v_cndmask_b32 v21, v21, v2, vcc
    v_mov_b32 v2, 0x3020c0c
    v_cmp_eq_u32 vcc, 1, v19
    s_nop 1
    v_cndmask_b32 v21, v21, v2, vcc
    v_mov_b32 v22, 0x0c0c0c0c
    v_mov_b32 v2, 0xc0c0100
    v_cmp_eq_u32 vcc, 2, v19
    s_nop 1
    v_cndmask_b32 v22, v22, v2, vcc
    v_mov_b32 v2, 0x1000c0c
    v_cmp_eq_u32 vcc, 3, v19
    s_nop 1
    v_cndmask_b32 v22, v22, v2, vcc
    v_mov_b32 v23, 0x0c0c0c0c
    v_mov_b32 v2, 0xc0c0302
    v_cmp_eq_u32 vcc, 2, v19
    s_nop 1
    v_cndmask_b32 v23, v23, v2, vcc
    v_mov_b32 v2, 0x3020c0c
    v_cmp_eq_u32 vcc, 3, v19
    s_nop 1
    v_cndmask_b32 v23, v23, v2, vcc
    v_lshrrev_b32 v19, 4, v5
    v_xor_b32 v7, v19, v5
    v_lshlrev_b32 v7, 4, v7
    v_lshlrev_b32 v2, 1, v19
    v_xor_b32 v8, v2, v5
    v_lshlrev_b32 v8, 4, v8
    v_lshlrev_b32 v12, 5, v19
    v_and_b32 v2, 4, v0
    v_lshl_or_b32 v12, v2, 2, v12
    v_and_b32 v2, 8, v0
    v_lshl_or_b32 v12, v2, 6, v12
    v_lshl_or_b32 v2, v4, 7, v18
    v_bfe_u32 v19, v0, 3, 3
    v_lshl_or_b32 v10, v19, 11, v2
    v_mul_u32_u24 v9, 0xe000, v17
    v_add_u32 v9, v9, v18
    v_bfe_u32 v19, v0, 4, 1
    v_lshl_or_b32 v19, v4, 1, v19
    v_mul_u32_u24 v13, 1536, v19
    v_lshl_add_u32 v13, v18, 1, v13
    v_bfe_u32 v19, v0, 5, 1
    v_lshl_add_u32 v13, v19, 8, v13
    v_lshlrev_b32 v19, 8, v19
    v_lshl_or_b32 v19, v4, 4, v19
    v_and_or_b32 v19, v0, 7, v19
    v_bfe_u32 v2, v0, 4, 1
    v_lshl_or_b32 v19, v2, 3, v19
    v_and_b32 v2, 7, v19
    v_lshrrev_b32 v19, 3, v19
    v_lshlrev_b32 v19, 14, v19
    v_lshl_or_b32 v14, v2, 4, v19
    s_lshl_b32 s64, s69, 8
    v_or_b32 v14, s64, v14
    s_and_b32 s64, s2, 1
    s_bfe_u32 s45, s2, 0x20001
    s_lshl2_add_u32 s45, s64, s45
    s_lshl_b32 s45, s45, 23
    s_lshr_b32 s64, s2, 3
    s_andn2_b32 s66, s2, 31
    s_add_u32 s64, s64, s66
    s_lshl2_add_u32 s64, s64, s3
    s_lshl_b32 s64, s64, 10
    s_add_u32 s45, s45, s64
    s_add_u32 s45, s45, 7340032
    s_mul_i32 s64, s3, 8704
    s_add_u32 m0, s64, 20480
    s_mul_i32 s66, s3, 9216
    s_add_u32 s66, s66, 55296
    s_lshl_b32 s53, s69, 17
    s_add_u32 s53, s53, s65
    s_mul_i32 s54, s69, 114688
    s_add_u32 s54, s54, s65
    s_and_b32 s56, s63, 3
    s_add_u32 s64, s67, 3
    s_and_b32 s64, s64, 7
    s_add_u32 s58, s56, s64
    s_add_u32 s57, s56, 4
    s_cmp_eq_u32 s56, 3
    s_cselect_b32 s57, s68, s57
    s_add_u32 s57, s57, s64
    s_sub_u32 s64, s57, 7
    s_min_u32 s57, s57, s64
    s_sub_u32 s64, s58, 7
    s_min_u32 s58, s58, s64
    s_mul_i32 s64, s67, 7
    s_add_u32 s57, s57, s64
    s_add_u32 s58, s58, s64
    s_mul_i32 s46, s68, 14336
    s_add_u32 s46, s46, s57
    s_lshl_b32 s46, s46, 7
    s_lshl_b32 s58, s58, 7
    s_add_u32 s64, s56, 1
    s_and_b32 s64, s64, 3
    s_lshl_b32 s64, s64, 7
    s_add_u32 s64, s64, s68
    s_mul_i32 s47, s64, 14336
    s_add_u32 s47, s47, s58
    s_lshl_b32 s37, s64, 2
    s_add_u32 s64, s56, 2
    s_and_b32 s64, s64, 3
    s_lshl_b32 s64, s64, 7
    s_add_u32 s64, s64, s68
    s_mul_i32 s52, s64, 14336
    s_add_u32 s52, s52, s58
    s_lshl_b32 s38, s64, 2
    s_add_u32 s64, s56, 3
    s_and_b32 s64, s64, 3
    s_lshl_b32 s64, s64, 7
    s_add_u32 s64, s64, s68
    s_mul_i32 s94, s64, 14336
    s_add_u32 s94, s94, s58
    s_lshl_b32 s39, s64, 2
    s_lshl_b32 s55, s68, 17
    s_add_u32 s55, s55, 1048576
    s_waitcnt lgkmcnt(0)
    s_mov_b32 s64, 524288
    s_load_dword s61, s[40:41], s64
    s_cmp_lt_u32 s63, 4
    s_cselect_b64 s[24:25], s[48:49], s[50:51]
    s_cselect_b64 s[32:33], s[50:51], s[48:49]
    s_bitcmp1_b32 s36, 0
    s_cbranch_scc1 L_deepx
    s_waitcnt vmcnt(5)
L_deepx:
    s_waitcnt vmcnt(8)
    v_perm_b32 v40, v28, v28, v20
    v_perm_b32 v41, v28, v28, v22
    v_perm_b32 v42, v28, v28, v21
    v_perm_b32 v43, v28, v28, v23
    v_perm_b32 v44, v29, v29, v20
    v_perm_b32 v45, v29, v29, v22
    v_perm_b32 v46, v29, v29, v21
    v_perm_b32 v47, v29, v29, v23
    v_perm_b32 v48, v30, v30, v20
    v_perm_b32 v49, v30, v30, v22
    v_perm_b32 v50, v30, v30, v21
    v_perm_b32 v51, v30, v30, v23
    v_perm_b32 v52, v31, v31, v20
    v_perm_b32 v53, v31, v31, v22
    v_perm_b32 v54, v31, v31, v21
    v_perm_b32 v55, v31, v31, v23
    s_cbranch_scc1 L_deep
    s_waitcnt vmcnt(4)
    buffer_load_dwordx4 v[148:151], v6, s[16:19], s44 offen nt
    s_addk_i32 s44, 8192
    s_waitcnt vmcnt(4)
    buffer_load_dwordx4 v[152:155], v6, s[16:19], s44 offen nt
    s_addk_i32 s44, 8192
    s_waitcnt vmcnt(4)
    buffer_load_dwordx4 v[156:159], v6, s[16:19], s44 offen nt
L_deep:
    buffer_load_dword v32, v11, s[4:7], s37 offen
    buffer_load_dword v33, v11, s[4:7], s38 offen
    buffer_load_dword v34, v11, s[4:7], s39 offen
    s_waitcnt vmcnt(7)
    buffer_load_dwordx4 v7, s[8:11], s45 offen nt lds
    s_xor_b32 s45, s45, 139264
    s_addk_i32 m0, 1088
    v_mfma_f32_16x16x16_bf16 v[72:75], v[40:41], v[128:129], 0
    v_mfma_f32_16x16x16_bf16 v[76:79], v[40:41], v[130:131], 0
    v_mfma_f32_16x16x16_bf16 v[72:75], v[42:43], v[132:133], v[72:75]
    v_mfma_f32_16x16x16_bf16 v[76:79], v[42:43], v[134:135], v[76:79]
    v_mfma_f32_16x16x16_bf16 v[72:75], v[44:45], v[136:137], v[72:75]
    v_mfma_f32_16x16x16_bf16 v[76:79], v[44:45], v[138:139], v[76:79]
    v_mfma_f32_16x16x16_bf16 v[72:75], v[46:47], v[140:141], v[72:75]
    v_mfma_f32_16x16x16_bf16 v[76:79], v[46:47], v[142:143], v[76:79]
    s_waitcnt vmcnt(7)
    buffer_load_dwordx4 v7, s[8:11], s45 offen nt lds
    s_xor_b32 s45, s45, 417792
    s_addk_i32 m0, 1088
    v_mfma_f32_16x16x16_bf16 v[72:75], v[48:49], v[144:145], v[72:75]
    v_mfma_f32_16x16x16_bf16 v[76:79], v[48:49], v[146:147], v[76:79]
    s_waitcnt vmcnt(7)
    buffer_load_dwordx4 v7, s[8:11], s45 offen nt lds
    s_xor_b32 s45, s45, 139264
    s_addk_i32 m0, 1088
    v_mfma_f32_16x16x16_bf16 v[72:75], v[50:51], v[148:149], v[72:75]
    v_mfma_f32_16x16x16_bf16 v[76:79], v[50:51], v[150:151], v[76:79]
    s_waitcnt vmcnt(7)
    buffer_load_dwordx4 v7, s[8:11], s45 offen nt lds
    s_xor_b32 s45, s45, 937984
    s_addk_i32 m0, 1088
    v_mfma_f32_16x16x16_bf16 v[72:75], v[52:53], v[152:153], v[72:75]
    v_mfma_f32_16x16x16_bf16 v[76:79], v[52:53], v[154:155], v[76:79]
    s_waitcnt vmcnt(7)
    buffer_load_dwordx4 v7, s[8:11], s45 offen nt lds
    s_xor_b32 s45, s45, 139264
    s_addk_i32 m0, 1088
    v_mfma_f32_16x16x16_bf16 v[72:75], v[54:55], v[156:157], v[72:75]
    v_mfma_f32_16x16x16_bf16 v[76:79], v[54:55], v[158:159], v[76:79]
    s_waitcnt lgkmcnt(0)
    s_add_u32 s61, s61, 0x01010101
    s_bfe_u32 s56, s61, 0x80000
    s_bfe_u32 s57, s61, 0x80008
    s_bfe_u32 s58, s61, 0x80010
    s_bfe_u32 s59, s61, 0x80018
    v_mov_b32 v24, s56
    v_mov_b32 v25, s57
    v_mov_b32 v26, s58
    v_mov_b32 v27, s59
    s_mov_b32 exec_lo, 0xff0000ff
    s_mov_b32 exec_hi, 0xff0000ff
    ds_write_b128 v13, v[72:75] offset:8192
    ds_write_b128 v13, v[76:79] offset:8208
    ds_add_u32 v1, v3 offset:0
    s_mov_b64 exec, -1
    s_waitcnt vmcnt(4)
    buffer_load_dwordx4 v7, s[8:11], s45 offen nt lds
    s_xor_b32 s45, s45, 417792
    s_addk_i32 m0, 1088
    s_waitcnt vmcnt(4)
    buffer_load_dwordx4 v7, s[8:11], s45 offen nt lds
    s_xor_b32 s45, s45, 139264
    s_addk_i32 m0, 1088
    v_perm_b32 v56, v32, v32, v20
    v_perm_b32 v57, v32, v32, v22
    v_perm_b32 v58, v32, v32, v21
    v_perm_b32 v59, v32, v32, v23
    v_perm_b32 v60, v33, v33, v20
    v_perm_b32 v61, v33, v33, v22
    v_perm_b32 v62, v33, v33, v21
    v_perm_b32 v63, v33, v33, v23
    v_perm_b32 v64, v34, v34, v20
    v_perm_b32 v65, v34, v34, v22
    v_perm_b32 v66, v34, v34, v21
    v_perm_b32 v67, v34, v34, v23
    s_waitcnt vmcnt(4)
    buffer_load_dwordx4 v7, s[8:11], s45 offen nt lds
    s_xor_b32 s45, s45, 937984
    s_mov_b32 m0, s66
    v_lshlrev_b32 v15, 24, v5
    v_mov_b32 v16, s61
    s_lshr_b32 s44, s2, 3
    s_lshl2_add_u32 s44, s44, s3
    s_lshl_b32 s64, s67, 10
    s_add_u32 s44, s44, s64
    s_lshl2_add_u32 s44, s44, 590336
    s_waitcnt vmcnt(4)
    buffer_load_dwordx4 v8, s[12:15], s45 offen nt lds
    s_xor_b32 s45, s45, 139264
    s_addk_i32 m0, 1152
    s_waitcnt vmcnt(4)
    buffer_load_dwordx4 v8, s[12:15], s45 offen nt lds
    s_xor_b32 s45, s45, 417792
    s_addk_i32 m0, 1152
    s_waitcnt vmcnt(4)
    buffer_load_dwordx4 v8, s[12:15], s45 offen nt lds
    s_xor_b32 s45, s45, 139264
    s_addk_i32 m0, 1152
    ds_add_u32 v1, v3 offset:3072
    s_waitcnt vmcnt(4)
    buffer_load_dwordx4 v8, s[12:15], s45 offen nt lds
    s_xor_b32 s45, s45, 937984
    s_addk_i32 m0, 1152
    s_waitcnt vmcnt(4)
    buffer_load_dwordx4 v8, s[12:15], s45 offen nt lds
    s_xor_b32 s45, s45, 139264
    s_addk_i32 m0, 1152
    ds_add_u32 v1, v3 offset:512
    s_waitcnt vmcnt(4)
    buffer_load_dwordx4 v8, s[12:15], s45 offen nt lds
    s_xor_b32 s45, s45, 417792
    s_addk_i32 m0, 1152
    s_waitcnt vmcnt(4)
    buffer_load_dwordx4 v8, s[12:15], s45 offen nt lds
    s_xor_b32 s45, s45, 139264
    s_addk_i32 m0, 1152
    s_mov_b32 s38, 0xff00ff
    s_mov_b32 s39, s38
    s_waitcnt vmcnt(4)
    buffer_load_dwordx4 v8, s[12:15], s45 offen nt lds
    s_waitcnt vmcnt(4)
    buffer_load_dwordx4 v[160:163], v9, s[24:27], s46 offen nt
    s_addk_i32 s46, 7168
    s_waitcnt vmcnt(4)
    buffer_load_dwordx4 v[164:167], v9, s[32:35], s47 offen nt
    s_addk_i32 s47, 7168
    s_waitcnt vmcnt(4)
    buffer_load_dwordx4 v[168:171], v9, s[24:27], s46 offen nt
    s_addk_i32 s46, 7168
    ds_add_u32 v1, v3 offset:256
    s_waitcnt vmcnt(4)
    buffer_load_dwordx4 v[172:175], v9, s[32:35], s47 offen nt
    s_waitcnt vmcnt(4)
    buffer_load_dwordx4 v[176:179], v9, s[24:27], s46 offen nt
    s_addk_i32 s46, 7168
    ds_add_u32 v1, v3 offset:768
    s_waitcnt vmcnt(4)
    buffer_load_dwordx4 v[180:183], v9, s[32:35], s52 offen nt
    s_addk_i32 s52, 7168
    v_mfma_f32_16x16x16_bf16 v[80:83], v[40:41], v[160:161], 0
    v_mfma_f32_16x16x16_bf16 v[84:87], v[40:41], v[162:163], 0
    s_waitcnt vmcnt(4)
    buffer_load_dwordx4 v[184:187], v9, s[24:27], s46 offen nt
    s_addk_i32 s46, 7168
    v_mfma_f32_16x16x16_bf16 v[88:91], v[56:57], v[164:165], 0
    v_mfma_f32_16x16x16_bf16 v[92:95], v[56:57], v[166:167], 0
    s_waitcnt vmcnt(4)
    buffer_load_dwordx4 v[188:191], v9, s[32:35], s52 offen nt
    v_mfma_f32_16x16x16_bf16 v[80:83], v[42:43], v[168:169], v[80:83]
    v_mfma_f32_16x16x16_bf16 v[84:87], v[42:43], v[170:171], v[84:87]
    s_waitcnt vmcnt(4)
    buffer_load_dwordx4 v[192:195], v9, s[24:27], s46 offen nt
    s_addk_i32 s46, 7168
    v_mfma_f32_16x16x16_bf16 v[88:91], v[58:59], v[172:173], v[88:91]
    v_mfma_f32_16x16x16_bf16 v[92:95], v[58:59], v[174:175], v[92:95]
    s_waitcnt vmcnt(4)
    buffer_load_dwordx4 v[196:199], v9, s[32:35], s94 offen nt
    s_addk_i32 s94, 7168
    v_mfma_f32_16x16x16_bf16 v[80:83], v[44:45], v[176:177], v[80:83]
    v_mfma_f32_16x16x16_bf16 v[84:87], v[44:45], v[178:179], v[84:87]
    s_waitcnt vmcnt(4)
    buffer_load_dwordx4 v[200:203], v9, s[24:27], s46 offen nt
    s_addk_i32 s46, 7168
    v_mfma_f32_16x16x16_bf16 v[88:91], v[60:61], v[180:181], v[88:91]
    v_mfma_f32_16x16x16_bf16 v[92:95], v[60:61], v[182:183], v[92:95]
    s_waitcnt vmcnt(4)
    buffer_load_dwordx4 v[204:207], v9, s[32:35], s94 offen nt
    v_mfma_f32_16x16x16_bf16 v[80:83], v[46:47], v[184:185], v[80:83]
    v_mfma_f32_16x16x16_bf16 v[84:87], v[46:47], v[186:187], v[84:87]
    s_waitcnt vmcnt(4)
    buffer_load_dwordx4 v[208:211], v9, s[24:27], s46 offen nt
    s_addk_i32 s46, 7168
    v_mfma_f32_16x16x16_bf16 v[88:91], v[62:63], v[188:189], v[88:91]
    v_mfma_f32_16x16x16_bf16 v[92:95], v[62:63], v[190:191], v[92:95]
    s_waitcnt vmcnt(4)
    buffer_load_dwordx4 v[212:215], v9, s[24:27], s46 offen nt
    v_mfma_f32_16x16x16_bf16 v[80:83], v[48:49], v[192:193], v[80:83]
    v_mfma_f32_16x16x16_bf16 v[84:87], v[48:49], v[194:195], v[84:87]
    s_waitcnt vmcnt(4)
    buffer_load_dwordx4 v[128:131], v10, s[20:23], s53 offen nt
    s_addk_i32 s53, 16384
    v_mfma_f32_16x16x16_bf16 v[88:91], v[64:65], v[196:197], v[88:91]
    v_mfma_f32_16x16x16_bf16 v[92:95], v[64:65], v[198:199], v[92:95]
    s_waitcnt vmcnt(4)
    buffer_load_dwordx4 v[132:135], v10, s[20:23], s53 offen nt
    s_addk_i32 s53, 16384
    v_mfma_f32_16x16x16_bf16 v[80:83], v[50:51], v[200:201], v[80:83]
    v_mfma_f32_16x16x16_bf16 v[84:87], v[50:51], v[202:203], v[84:87]
    s_waitcnt vmcnt(4)
    buffer_load_dwordx4 v[136:139], v10, s[20:23], s53 offen nt
    s_addk_i32 s53, 16384
    v_mfma_f32_16x16x16_bf16 v[88:91], v[66:67], v[204:205], v[88:91]
    v_mfma_f32_16x16x16_bf16 v[92:95], v[66:67], v[206:207], v[92:95]
    s_waitcnt vmcnt(4)
    buffer_load_dwordx4 v[140:143], v10, s[20:23], s53 offen nt
    s_addk_i32 s53, 16384
    v_mfma_f32_16x16x16_bf16 v[80:83], v[52:53], v[208:209], v[80:83]
    v_mfma_f32_16x16x16_bf16 v[84:87], v[52:53], v[210:211], v[84:87]
    s_waitcnt vmcnt(4)
    buffer_load_dwordx4 v[144:147], v10, s[20:23], s53 offen nt
    s_addk_i32 s53, 16384
    v_mfma_f32_16x16x16_bf16 v[80:83], v[54:55], v[212:213], v[80:83]
    v_mfma_f32_16x16x16_bf16 v[84:87], v[54:55], v[214:215], v[84:87]
    s_mov_b32 exec_lo, 0xff0000ff
    s_mov_b32 exec_hi, 0xff0000ff
    s_nop 4
    ds_write_b128 v13, v[80:83] offset:8704
    ds_write_b128 v13, v[84:87] offset:8720
    ds_write_b128 v13, v[88:91] offset:9216
    ds_write_b128 v13, v[92:95] offset:9232
    ds_add_u32 v1, v3 offset:1024
    s_mov_b64 exec, -1
    s_waitcnt vmcnt(4)
    buffer_load_dwordx4 v[148:151], v10, s[20:23], s53 offen nt
    s_addk_i32 s53, 16384
    s_waitcnt vmcnt(4)
    buffer_load_dwordx4 v[152:155], v10, s[20:23], s53 offen nt
    s_addk_i32 s53, 16384
    v_swap_b32 v130, v132
    v_swap_b32 v131, v133
    s_waitcnt vmcnt(4)
    buffer_load_dwordx4 v[156:159], v10, s[20:23], s53 offen nt
    s_waitcnt vmcnt(4)
    buffer_load_dwordx4 v[216:219], v10, s[28:31], s54 offen nt
    s_addk_i32 s54, 16384
    v_swap_b32 v138, v140
    v_swap_b32 v139, v141
    s_waitcnt vmcnt(4)
    buffer_load_dwordx4 v[220:223], v10, s[28:31], s54 offen nt
    s_addk_i32 s54, 16384
    s_waitcnt vmcnt(4)
    buffer_load_dwordx4 v[224:227], v10, s[28:31], s54 offen nt
    s_addk_i32 s54, 16384
    v_swap_b32 v146, v148
    v_swap_b32 v147, v149
    ds_add_u32 v1, v3 offset:1280
    s_waitcnt vmcnt(4)
    buffer_load_dwordx4 v[228:231], v10, s[28:31], s54 offen nt
    s_addk_i32 s54, 16384
    ds_add_u32 v1, v3 offset:3584
    s_waitcnt vmcnt(4)
    buffer_load_dwordx4 v[232:235], v10, s[28:31], s54 offen nt
    s_addk_i32 s54, 16384
    v_swap_b32 v154, v156
    v_swap_b32 v155, v157
    ds_add_u32 v1, v3 offset:1536
    s_waitcnt vmcnt(4)
    buffer_load_dwordx4 v[236:239], v10, s[28:31], s54 offen nt
    s_addk_i32 s54, 16384
    s_waitcnt vmcnt(4)
    buffer_load_dwordx4 v[240:243], v10, s[28:31], s54 offen nt
    v_swap_b32 v218, v220
    v_swap_b32 v219, v221
L_spin_1:
    ds_read_b32 v2, v1 offset:2560
    ds_read_b128 v[28:31], v12 offset:4608
    s_waitcnt lgkmcnt(0)
    v_readfirstlane_b32 s64, v2
    v_perm_b32 v40, v28, v28, v20
    v_perm_b32 v41, v28, v28, v22
    v_perm_b32 v42, v28, v28, v21
    v_perm_b32 v43, v28, v28, v23
    s_cmp_ge_u32 s64, 2
    s_cbranch_scc1 L_done_2
    s_sub_u32 s60, s60, 1
    s_cbranch_scc0 L_spin_1
    s_endpgm
L_done_2:
    v_mfma_f32_16x16x32_bf16 v[96:99], v[40:43], v[128:131], 0
    v_perm_b32 v44, v29, v29, v20
    v_perm_b32 v45, v29, v29, v22
    v_perm_b32 v46, v29, v29, v21
    v_perm_b32 v47, v29, v29, v23
    v_mfma_f32_16x16x32_bf16 v[100:103], v[40:43], v[132:135], 0
    s_nop 0
    v_mfma_f32_16x16x32_bf16 v[96:99], v[44:47], v[136:139], v[96:99]
    v_perm_b32 v48, v30, v30, v20
    v_perm_b32 v49, v30, v30, v22
    v_perm_b32 v50, v30, v30, v21
    v_perm_b32 v51, v30, v30, v23
    v_mfma_f32_16x16x32_bf16 v[100:103], v[44:47], v[140:143], v[100:103]
    s_nop 0
    v_mfma_f32_16x16x32_bf16 v[96:99], v[48:51], v[144:147], v[96:99]
    v_perm_b32 v52, v31, v31, v20
    v_perm_b32 v53, v31, v31, v22
    v_perm_b32 v54, v31, v31, v21
    v_perm_b32 v55, v31, v31, v23
    v_mfma_f32_16x16x32_bf16 v[100:103], v[48:51], v[148:151], v[100:103]
    s_nop 0
    v_mfma_f32_16x16x32_bf16 v[96:99], v[52:55], v[152:155], v[96:99]
    v_mfma_f32_16x16x32_bf16 v[100:103], v[52:55], v[156:159], v[100:103]
    s_waitcnt vmcnt(3)
    v_swap_b32 v226, v228
    v_swap_b32 v227, v229
    s_waitcnt vmcnt(1)
    v_swap_b32 v234, v236
    v_swap_b32 v235, v237
L_spin_3:
    ds_read_b32 v2, v1 offset:2816
    ds_read_b128 v[28:31], v12 offset:4736
    s_waitcnt lgkmcnt(0)
    v_readfirstlane_b32 s64, v2
    v_perm_b32 v40, v28, v28, v20
    v_perm_b32 v41, v28, v28, v22
    v_perm_b32 v42, v28, v28, v21
    v_perm_b32 v43, v28, v28, v23
    s_cmp_ge_u32 s64, 1
    s_cbranch_scc1 L_done_4
    s_sub_u32 s60, s60, 1
    s_cbranch_scc0 L_spin_3
    s_endpgm
L_done_4:
    v_mfma_f32_16x16x32_bf16 v[96:99], v[40:43], v[216:219], v[96:99]
    v_perm_b32 v44, v29, v29, v20
    v_perm_b32 v45, v29, v29, v22
    v_perm_b32 v46, v29, v29, v21
    v_perm_b32 v47, v29, v29, v23
    v_mfma_f32_16x16x32_bf16 v[100:103], v[40:43], v[220:223], v[100:103]
    s_nop 0
    v_mfma_f32_16x16x32_bf16 v[96:99], v[44:47], v[224:227], v[96:99]
    v_perm_b32 v48, v30, v30, v20
    v_perm_b32 v49, v30, v30, v22
    v_perm_b32 v50, v30, v30, v21
    v_perm_b32 v51, v30, v30, v23
    v_mfma_f32_16x16x32_bf16 v[100:103], v[44:47], v[228:231], v[100:103]
    buffer_store_dword v16, v15, s[40:43], s44 offen
    v_mfma_f32_16x16x32_bf16 v[96:99], v[48:51], v[232:235], v[96:99]
    v_perm_b32 v52, v31, v31, v20
    v_perm_b32 v53, v31, v31, v22
    v_mfma_f32_16x16x32_bf16 v[100:103], v[48:51], v[236:239], v[100:103]
    s_waitcnt vmcnt(1)
    s_nop 1
    v_mfma_f32_16x16x16_bf16 v[96:99], v[52:53], v[240:241], v[96:99]
    s_nop 1
    v_mfma_f32_16x16x16_bf16 v[100:103], v[52:53], v[242:243], v[100:103]
    s_nop 7
    v_permlane16_swap_b32 v96, v100
    v_permlane16_swap_b32 v97, v101
    v_permlane16_swap_b32 v98, v102
    v_permlane16_swap_b32 v99, v103
    v_add_f32_dpp v104, v100, v96 row_ror:8 row_mask:0xf bank_mask:0xf
    v_add_f32_dpp v105, v101, v97 row_ror:8 row_mask:0xf bank_mask:0xf
    v_add_f32_dpp v106, v102, v98 row_ror:8 row_mask:0xf bank_mask:0xf
    v_add_f32_dpp v107, v103, v99 row_ror:8 row_mask:0xf bank_mask:0xf
    v_and_or_b32 v104, v104, s62, v24
    v_and_or_b32 v105, v105, s62, v25
    v_and_or_b32 v106, v106, s62, v26
    v_and_or_b32 v107, v107, s62, v27
    s_mov_b64 exec, s[38:39]
    buffer_store_dwordx4 v[104:107], v14, s[40:43], s55 offen sc1
    ds_add_u32 v1, v3 offset:1792
    s_endpgm
L_B:
    s_mov_b32 s66, 524288
    s_load_dword s61, s[40:41], s66
    s_and_b32 s3, s3, 3
    s_mov_b32 s34, 2048
    s_mov_b32 s35, 0x20000
    s_mov_b32 s38, 4096
    s_mov_b32 s39, 0x20000
    s_mov_b32 s42, 6291456
    s_mov_b32 s43, 0x20000
    v_and_b32 v2, 31, v5
    v_lshlrev_b32 v20, 4, v2
    v_lshrrev_b32 v21, 5, v5
    v_lshl_or_b32 v6, v21, 11, v20
    s_lshl_b32 s65, s3, 9
    buffer_load_dwordx4 v[212:215], v6, s[4:7], s65 offen
    buffer_load_dwordx4 v[216:219], v20, s[32:35], s65 offen
    s_lshl_b32 s16, s67, 12
    s_add_u32 s16, s16, 655360
    v_lshlrev_b32 v251, 6, v5
    s_lshl_b32 s29, s67, 8
    s_add_u32 s29, s29, 720896
    v_lshrrev_b32 v253, 2, v20
    buffer_load_dword v254, v253, s[40:43], s29 offen
    s_mov_b32 s60, 200000
    s_mov_b32 s62, 0xffffff00
    v_lshlrev_b32 v1, 2, v5
    v_mov_b32 v3, 1
    v_lshrrev_b32 v18, 4, v5
    v_and_b32 v19, 15, v5
    v_lshlrev_b32 v7, 4, v5
    s_and_b32 s50, s2, 1
    s_bfe_u32 s51, s2, 0x20001
    s_lshl_b32 s64, s3, 1
    v_add_u32 v22, s64, v21
    v_mul_u32_u24 v8, 288, v22
    v_lshl_add_u32 v8, v2, 3, v8
    v_and_b32 v23, 7, v5
    v_mul_u32_u24 v9, 288, v23
    v_lshl_add_u32 v9, v18, 4, v9
    s_mul_i32 s64, s3, 8704
    v_mul_u32_u24 v10, 528, v19
    v_lshl_add_u32 v10, v18, 4, v10
    v_add_u32 v10, s64, v10
    v_bfe_u32 v24, v5, 2, 2
    v_and_b32 v25, 3, v5
    v_mul_u32_u24 v16, 1088, v24
    v_lshl_add_u32 v16, v25, 8, v16
    v_xor_b32 v2, v18, v25
    v_lshl_add_u32 v16, v2, 4, v16
    v_add_u32 v16, s64, v16
    s_mul_i32 s64, s3, 9216
    s_add_u32 s64, s64, 55296
    v_mul_u32_u24 v26, 1152, v18
    v_lshl_add_u32 v26, v24, 8, v26
    v_lshl_add_u32 v26, v25, 3, v26
    v_add_u32 v26, s64, v26
    v_xor_b32 v2, 0, v24
    v_lshl_add_u32 v220, v2, 5, v26
    v_xor_b32 v2, 1, v24
    v_lshl_add_u32 v221, v2, 5, v26
    v_xor_b32 v2, 2, v24
    v_lshl_add_u32 v222, v2, 5, v26
    v_xor_b32 v2, 3, v24
    v_lshl_add_u32 v223, v2, 5, v26
    s_lshl_b32 s64, s3, 2
    v_lshl_add_u32 v11, v23, 5, s64
    v_add_u32 v11, 4352, v11
    v_lshl_add_u32 v15, v21, 4, s64
    s_lshl_b32 s64, s3, 1
    v_and_or_b32 v22, v18, 1, s64
    v_mul_u32_u24 v12, 528, v22
    v_lshl_add_u32 v12, v19, 5, v12
    v_lshl_add_u32 v12, v21, 4, v12
    v_lshlrev_b32 v13, 5, v22
    v_lshlrev_b32 v232, 15, v18
    v_lshl_or_b32 v232, v19, 4, v232
    v_lshl_add_u32 v233, v18, 8, v7
    v_mov_b32 v172, 0x3f803f80
    v_mov_b32 v173, 0x3f803f80
    v_mov_b32 v174, 0x3f803f80
    v_mov_b32 v175, 0x3f803f80
    s_lshl_b32 s53, s67, 15
    s_lshl_b32 s64, s3, 11
    s_add_u32 s53, s53, s64
    s_add_u32 s54, s53, 8192
    s_add_u32 s55, s53, 16384
    s_add_u32 s48, s53, 24576
    s_waitcnt lgkmcnt(0)
    s_add_u32 s61, s61, 0x01010101
    s_bfe_u32 s56, s61, 0x80000
    s_bfe_u32 s57, s61, 0x80008
    s_bfe_u32 s58, s61, 0x80010
    s_bfe_u32 s59, s61, 0x80018
    v_mov_b32 v31, s61
    s_mul_i32 s18, s56, 0x01010101
    s_mov_b32 s19, s18
    s_getreg_b32 s28, hwreg(HW_REG_XCC_ID, 0, 4)
    s_xor_b32 s28, s28, s61
    s_lshr_b32 s64, s2, 3
    s_lshl2_add_u32 s64, s64, s29
    v_mov_b32 v2, s28
    s_mov_b64 exec, 1
    buffer_store_dword v2, v1, s[40:43], s64 offen
    s_mov_b64 exec, -1
    s_lshl_b32 s64, s63, 9
    s_add_u32 s64, s64, 65024
    v_mov_b32 v2, s64
    v_cmp_gt_u32 vcc, 8, v5
    s_nop 1
    v_cndmask_b32 v2, 0, v2, vcc
    v_lshl_add_u32 v2, v23, 4, v2
    s_lshl_b32 s64, s68, 7
    s_add_u32 s64, s64, s16
    s_sub_u32 s64, s64, 65024
    v_not_b32 v32, s18
    v_not_b32 v33, s18
    v_not_b32 v34, s18
    v_not_b32 v35, s18
    s_mov_b64 exec, 0xffff
    buffer_store_dwordx4 v[32:35], v2, s[40:43], s64 offen
    s_mov_b64 exec, -1
    s_waitcnt vmcnt(2)
    v_dot2_f32_bf16 v24, v212, v216, 0
    s_nop 2
    v_dot2_f32_bf16 v24, v213, v217, v24
    s_nop 2
    v_dot2_f32_bf16 v24, v214, v218, v24
    s_nop 2
    v_dot2_f32_bf16 v24, v215, v219, v24
    s_nop 2
    v_add_f32_dpp v24, v24, v24 row_ror:1 row_mask:0xf bank_mask:0xf
    s_nop 1
    v_add_f32_dpp v24, v24, v24 row_ror:2 row_mask:0xf bank_mask:0xf
    s_nop 1
    v_add_f32_dpp v24, v24, v24 row_ror:4 row_mask:0xf bank_mask:0xf
    s_nop 1
    v_add_f32_dpp v24, v24, v24 row_ror:8 row_mask:0xf bank_mask:0xf
    v_mov_b32 v25, v24
    s_nop 1
    v_permlane16_swap_b32 v24, v25
    v_add_f32 v24, v24, v25
    ds_write_b32 v15, v24 offset:4096
    v_mov_b32 v224, s56
    v_mov_b32 v225, s57
    v_mov_b32 v226, s58
    v_mov_b32 v227, s59
    s_cmp_lg_u32 s3, 3
    s_cbranch_scc1 L_noQpub
    s_xor_b32 s64, s67, 2
    s_add_u32 s65, s64, 8
    s_cmp_eq_u32 s63, 3
    s_cselect_b32 s65, s65, s69
    s_cmp_eq_u32 s64, 3
    s_mul_i32 s64, s63, 8
    s_bitset1_b32 s64, 0
    s_bitset1_b32 s64, 1
    s_cselect_b32 s65, s64, s65
    s_and_b32 s64, s2, 8
    s_xor_b32 s65, s65, s64
    s_lshr_b32 s49, s65, 4
    s_xor_b32 s30, s49, s51
    s_mov_b32 s31, 0
    s_add_u32 s44, s29, 64
    s_add_u32 s45, s29, 96
    s_mov_b32 s46, s28
    s_mov_b32 s47, s28
    s_lshl_b32 s52, s50, 4
    s_lshl_b32 s52, 0xffff, s52
    s_and_b32 s65, s65, 15
    s_lshl4_add_u32 s65, s68, s65
    s_lshl_b32 s65, s65, 9
    s_lshl_b32 s49, s49, 16
    s_add_u32 s49, s49, s65
L_spin_5:
    ds_read_b32 v2, v1 offset:0
    s_waitcnt lgkmcnt(0)
    v_readfirstlane_b32 s64, v2
    s_nop 0
    s_cmp_ge_u32 s64, 4
    s_cbranch_scc1 L_done_6
    s_sub_u32 s60, s60, 1
    s_cbranch_scc0 L_spin_5
    s_endpgm
L_done_6:
    s_mov_b32 exec_hi, 0
    s_load_dwordx16 s[72:87], s[40:41], s29
    s_load_dwordx8 s[8:15], s[40:41], s44
    s_load_dwordx8 s[20:27], s[40:41], s45
    ds_read_b128 v[32:35], v7 offset:8192
    ds_read_b128 v[36:39], v7 offset:9728
    ds_read_b128 v[40:43], v7 offset:11264
    ds_read_b128 v[44:47], v7 offset:12800
    ds_read_b128 v[48:51], v7 offset:14336
    ds_read_b128 v[52:55], v7 offset:15872
    ds_read_b128 v[56:59], v7 offset:17408
    ds_read_b128 v[60:63], v7 offset:18944
    s_waitcnt lgkmcnt(0)
    v_pk_add_f32 v[32:33], v[32:33], v[48:49]
    v_pk_add_f32 v[34:35], v[34:35], v[50:51]
    v_pk_add_f32 v[36:37], v[36:37], v[52:53]
    v_pk_add_f32 v[38:39], v[38:39], v[54:55]
    v_pk_add_f32 v[40:41], v[40:41], v[56:57]
    v_pk_add_f32 v[42:43], v[42:43], v[58:59]
    v_pk_add_f32 v[44:45], v[44:45], v[60:61]
    v_pk_add_f32 v[46:47], v[46:47], v[62:63]
    v_pk_add_f32 v[32:33], v[32:33], v[40:41]
    v_pk_add_f32 v[34:35], v[34:35], v[42:43]
    v_pk_add_f32 v[36:37], v[36:37], v[44:45]
    v_pk_add_f32 v[38:39], v[38:39], v[46:47]
    v_pk_add_f32 v[32:33], v[32:33], v[36:37]
    v_pk_add_f32 v[34:35], v[34:35], v[38:39]
    v_and_or_b32 v32, v32, s62, v224
    v_and_or_b32 v33, v33, s62, v225
    v_and_or_b32 v34, v34, s62, v226
    v_and_or_b32 v35, v35, s62, v227
    s_not_b32 exec_lo, s52
    buffer_store_dwordx4 v[32:35], v232, s[40:43], s49 offen sc1
    s_xor_b64 s[72:73], s[72:73], s[46:47]
    s_or_b64 s[30:31], s[30:31], s[72:73]
    s_xor_b64 s[74:75], s[74:75], s[46:47]
    s_or_b64 s[30:31], s[30:31], s[74:75]
    s_xor_b64 s[76:77], s[76:77], s[46:47]
    s_or_b64 s[30:31], s[30:31], s[76:77]
    s_xor_b64 s[78:79], s[78:79], s[46:47]
    s_or_b64 s[30:31], s[30:31], s[78:79]
    s_xor_b64 s[80:81], s[80:81], s[46:47]
    s_or_b64 s[30:31], s[30:31], s[80:81]
    s_xor_b64 s[82:83], s[82:83], s[46:47]
    s_or_b64 s[30:31], s[30:31], s[82:83]
    s_xor_b64 s[84:85], s[84:85], s[46:47]
    s_or_b64 s[30:31], s[30:31], s[84:85]
    s_xor_b64 s[86:87], s[86:87], s[46:47]
    s_or_b64 s[30:31], s[30:31], s[86:87]
    s_xor_b64 s[8:9], s[8:9], s[46:47]
    s_or_b64 s[30:31], s[30:31], s[8:9]
    s_xor_b64 s[10:11], s[10:11], s[46:47]
    s_or_b64 s[30:31], s[30:31], s[10:11]
    s_xor_b64 s[12:13], s[12:13], s[46:47]
    s_or_b64 s[30:31], s[30:31], s[12:13]
    s_xor_b64 s[14:15], s[14:15], s[46:47]
    s_or_b64 s[30:31], s[30:31], s[14:15]
    s_xor_b64 s[20:21], s[20:21], s[46:47]
    s_or_b64 s[30:31], s[30:31], s[20:21]
    s_xor_b64 s[22:23], s[22:23], s[46:47]
    s_or_b64 s[30:31], s[30:31], s[22:23]
    s_xor_b64 s[24:25], s[24:25], s[46:47]
    s_or_b64 s[30:31], s[30:31], s[24:25]
    s_xor_b64 s[26:27], s[26:27], s[46:47]
    s_or_b64 s[30:31], s[30:31], s[26:27]
    s_mov_b32 exec_lo, s52
    s_cmp_eq_u64 s[30:31], 0
    s_cbranch_scc0 L_far_7
    buffer_store_dwordx4 v[32:35], v232, s[40:43], s49 offen
L_back_8:
    s_lshr_b32 s64, s2, 3
    s_add_u32 s64, s64, s16
    s_mov_b64 exec, 0xffff
    buffer_store_byte v31, v251, s[40:43], s64 offen offset:0
    s_mov_b64 exec, -1
L_noQpub:
    v_mov_b32 v250, 0
    s_mov_b32 s49, 0xffff0000
    s_mov_b32 s46, 0x3db504f3
    s_mov_b32 s47, s46
    s_mov_b32 s52, 0x3fb8aa3b
    s_lshl2_add_u32 s65, s51, s3
    s_lshl3_add_u32 s65, s65, s50
    s_lshl_b32 s65, s65, 5
    s_lshr_b32 s66, s2, 3
    s_lshl1_add_u32 s45, s65, s66
    s_add_u32 s65, s65, s66
    s_lshl_b32 s44, s65, 8
    s_add_u32 s44, s44, 2097152
    s_lshl_b32 s45, s45, 4
    s_add_u32 s45, s45, 262656
    v_bfe_u32 v2, v5, 3, 2
    v_lshlrev_b32 v14, 14, v2
    v_lshl_or_b32 v14, v23, 4, v14
    v_lshlrev_b32 v232, 11, v2
    s_mov_b32 s65, 35128600
    v_mul_lo_u32 v228, v23, s65
    v_add_u32 v231, 1338470137, v228
    v_add_u32 v230, 1329687987, v228
    v_add_u32 v229, 1320905837, v228
    v_add_u32 v228, 1312123687, v228
L_spin_12:
    ds_read_b32 v2, v1 offset:3072
    s_waitcnt lgkmcnt(0)
    v_readfirstlane_b32 s64, v2
    s_nop 0
    s_cmp_ge_u32 s64, 4
    s_cbranch_scc1 L_done_13
    s_sub_u32 s60, s60, 1
    s_cbranch_scc0 L_spin_12
    s_endpgm
L_done_13:
    s_add_u32 s17, s16, 0
L_hint_9:
    s_load_dwordx8 s[8:15], s[40:41], s17
    ds_read_b32 v2, v1 offset:256
    s_add_u32 s17, s17, 64
    s_waitcnt lgkmcnt(0)
    v_readfirstlane_b32 s64, v2
    s_xor_b64 s[8:9], s[8:9], s[18:19]
    s_xor_b64 s[10:11], s[10:11], s[18:19]
    s_xor_b64 s[12:13], s[12:13], s[18:19]
    s_xor_b64 s[14:15], s[14:15], s[18:19]
    s_cmp_ge_u32 s64, 4
    s_cbranch_scc1 L_hdone_10
    s_or_b64 s[8:9], s[8:9], s[10:11]
    s_or_b64 s[12:13], s[12:13], s[14:15]
    s_or_b64 s[8:9], s[8:9], s[12:13]
    s_cbranch_scc0 L_hx_11
    s_and_b32 s64, s17, 1023
    s_cbranch_scc1 L_hint_9
L_spin_14:
    ds_read_b32 v2, v1 offset:256
    s_waitcnt lgkmcnt(0)
    v_readfirstlane_b32 s64, v2
    s_nop 0
    s_cmp_ge_u32 s64, 4
    s_cbranch_scc1 L_done_15
    s_sub_u32 s60, s60, 1
    s_cbranch_scc0 L_spin_14
    s_endpgm
L_done_15:
L_hx_11:
L_hdone_10:
    buffer_load_dword v252, v253, s[40:43], s29 offen sc1
    buffer_load_dwordx4 v[128:131], v233, s[40:43], s53 offen sc1
    buffer_load_dwordx4 v[132:135], v233, s[40:43], s54 offen sc1
    buffer_load_dwordx4 v[136:139], v233, s[40:43], s55 offen sc1
    buffer_load_dwordx4 v[140:143], v233, s[40:43], s48 offen sc1
L_spin_16:
    ds_read_b32 v2, v1 offset:512
    s_waitcnt lgkmcnt(0)
    v_readfirstlane_b32 s64, v2
    s_nop 0
    s_cmp_ge_u32 s64, 4
    s_cbranch_scc1 L_done_17
    s_sub_u32 s60, s60, 1
    s_cbranch_scc0 L_spin_16
    s_endpgm
L_done_17:
    ds_read_b128 v[32:35], v16 offset:20480
    ds_read_b128 v[36:39], v16 offset:20544
    ds_read_b128 v[40:43], v16 offset:20608
    ds_read_b128 v[44:47], v16 offset:20672
    ds_read_b128 v[48:51], v16 offset:24832
    ds_read_b128 v[52:55], v16 offset:24896
    ds_read_b128 v[56:59], v16 offset:24960
    ds_read_b128 v[60:63], v16 offset:25024
L_qcheck:
    s_waitcnt vmcnt(3)
    v_xor_b32 v128, s56, v128
    v_xor_b32 v129, s57, v129
    v_xor_b32 v130, s58, v130
    v_xor_b32 v131, s59, v131
    v_or3_b32 v2, v128, v129, 0
    v_or3_b32 v2, v130, v131, v2
    s_waitcnt vmcnt(2)
    v_xor_b32 v132, s56, v132
    v_xor_b32 v133, s57, v133
    v_xor_b32 v134, s58, v134
    v_xor_b32 v135, s59, v135
    v_or3_b32 v2, v132, v133, v2
    v_or3_b32 v2, v134, v135, v2
    v_pk_add_f32 v[128:129], v[128:129], v[132:133]
    v_pk_add_f32 v[130:131], v[130:131], v[134:135]
    s_waitcnt vmcnt(1)
    v_xor_b32 v136, s56, v136
    v_xor_b32 v137, s57, v137
    v_xor_b32 v138, s58, v138
    v_xor_b32 v139, s59, v139
    v_or3_b32 v2, v136, v137, v2
    v_or3_b32 v2, v138, v139, v2
    v_pk_add_f32 v[128:129], v[128:129], v[136:137]
    v_pk_add_f32 v[130:131], v[130:131], v[138:139]
    s_waitcnt vmcnt(0)
    v_xor_b32 v140, s56, v140
    v_xor_b32 v141, s57, v141
    v_xor_b32 v142, s58, v142
    v_xor_b32 v143, s59, v143
    v_or3_b32 v2, v140, v141, v2
    v_or3_b32 v2, v142, v143, v2
    v_cmp_ne_u32_sdwa vcc, v2, v250 src0_sel:BYTE_0 src1_sel:DWORD
    v_pk_add_f32 v[128:129], v[128:129], v[140:141]
    v_pk_add_f32 v[130:131], v[130:131], v[142:143]
    s_cbranch_vccnz L_qretry
    v_cvt_pk_bf16_f32 v128, v128, v129
    v_cvt_pk_bf16_f32 v129, v130, v131
    ds_write_b64 v8, v[128:129] offset:5632
    ds_add_u32 v1, v3 offset:2048
    v_cmp_ne_u32 s[30:31], s28, v252
L_spin_18:
    ds_read_b32 v2, v1 offset:2048
    ds_read_b128 v[144:147], v9 offset:5632
    ds_read_b128 v[148:151], v9 offset:5696
    ds_read_b128 v[152:155], v9 offset:5760
    ds_read_b128 v[156:159], v9 offset:5824
    s_waitcnt lgkmcnt(0)
    v_readfirstlane_b32 s64, v2
    s_nop 0
    s_cmp_ge_u32 s64, 4
    s_cbranch_scc1 L_done_19
    s_sub_u32 s60, s60, 1
    s_cbranch_scc0 L_spin_18
    s_endpgm
L_done_19:
    v_mfma_f32_16x16x32_bf16 v[160:163], v[32:35], v[144:147], 0
    v_mfma_f32_16x16x32_bf16 v[164:167], v[48:51], v[144:147], 0
    v_mfma_f32_16x16x32_bf16 v[160:163], v[36:39], v[148:151], v[160:163]
    v_mfma_f32_16x16x32_bf16 v[164:167], v[52:55], v[148:151], v[164:167]
    v_mfma_f32_16x16x32_bf16 v[160:163], v[40:43], v[152:155], v[160:163]
    v_mfma_f32_16x16x32_bf16 v[164:167], v[56:59], v[152:155], v[164:167]
    v_mfma_f32_16x16x32_bf16 v[160:163], v[44:47], v[156:159], v[160:163]
    v_mfma_f32_16x16x32_bf16 v[164:167], v[60:63], v[156:159], v[164:167]
    s_nop 6
    v_cvt_pk_bf16_f32 v168, v160, v161
    v_cvt_pk_bf16_f32 v169, v162, v163
    v_cvt_pk_bf16_f32 v170, v164, v165
    v_cvt_pk_bf16_f32 v171, v166, v167
    v_lshlrev_b32 v160, 16, v168
    v_and_b32 v161, s49, v168
    v_lshlrev_b32 v162, 16, v169
    v_and_b32 v163, s49, v169
    v_lshlrev_b32 v164, 16, v170
    v_and_b32 v165, s49, v170
    v_lshlrev_b32 v166, 16, v171
    v_and_b32 v167, s49, v171
    v_pk_mul_f32 v[160:161], v[160:161], s[46:47]
    v_pk_mul_f32 v[162:163], v[162:163], s[46:47]
    v_pk_mul_f32 v[164:165], v[164:165], s[46:47]
    v_pk_mul_f32 v[166:167], v[166:167], s[46:47]
    v_cvt_pk_bf16_f32 v168, v160, v161
    v_cvt_pk_bf16_f32 v169, v162, v163
    v_cvt_pk_bf16_f32 v170, v164, v165
    v_cvt_pk_bf16_f32 v171, v166, v167
    v_lshlrev_b32 v160, 16, v168
    v_and_b32 v161, s49, v168
    v_lshlrev_b32 v162, 16, v169
    v_and_b32 v163, s49, v169
    v_lshlrev_b32 v164, 16, v170
    v_and_b32 v165, s49, v170
    v_lshlrev_b32 v166, 16, v171
    v_and_b32 v167, s49, v171
    v_max3_f32 v24, v160, v161, v162
    v_max3_f32 v25, v163, v164, v165
    v_max3_f32 v24, v24, v166, v167
    v_max_f32 v24, v24, v25
    v_mov_b32 v25, v24
    s_nop 1
    v_permlane16_swap_b32 v24, v25
    v_max_f32 v24, v24, v25
    v_mov_b32 v25, v24
    s_nop 1
    v_permlane32_swap_b32 v24, v25
    v_max_f32 v24, v24, v25
    v_mul_f32 v24, s52, v24
    v_fma_f32 v160, v160, s52, -v24
    v_fma_f32 v161, v161, s52, -v24
    v_fma_f32 v162, v162, s52, -v24
    v_fma_f32 v163, v163, s52, -v24
    v_fma_f32 v164, v164, s52, -v24
    v_fma_f32 v165, v165, s52, -v24
    v_fma_f32 v166, v166, s52, -v24
    v_fma_f32 v167, v167, s52, -v24
    v_exp_f32 v160, v160
    v_exp_f32 v161, v161
    v_exp_f32 v162, v162
    v_exp_f32 v163, v163
    v_exp_f32 v164, v164
    v_exp_f32 v165, v165
    v_exp_f32 v166, v166
    v_exp_f32 v167, v167
    v_cvt_pk_bf16_f32 v168, v160, v161
    v_cvt_pk_bf16_f32 v169, v162, v163
    v_cvt_pk_bf16_f32 v170, v164, v165
    v_cvt_pk_bf16_f32 v171, v166, v167
L_spin_20:
    ds_read_b32 v2, v1 offset:768
    s_waitcnt lgkmcnt(0)
    v_readfirstlane_b32 s64, v2
    s_nop 0
    s_cmp_ge_u32 s64, 4
    s_cbranch_scc1 L_done_21
    s_sub_u32 s60, s60, 1
    s_cbranch_scc0 L_spin_20
    s_endpgm
L_done_21:
    ds_read_b64_tr_b16 v[96:97], v220 offset:0
    ds_read_b64_tr_b16 v[98:99], v220 offset:4608
    ds_read_b64_tr_b16 v[100:101], v221 offset:0
    ds_read_b64_tr_b16 v[102:103], v221 offset:4608
    ds_read_b64_tr_b16 v[104:105], v222 offset:0
    ds_read_b64_tr_b16 v[106:107], v222 offset:4608
    ds_read_b64_tr_b16 v[108:109], v223 offset:0
    ds_read_b64_tr_b16 v[110:111], v223 offset:4608
    ds_read_b64_tr_b16 v[112:113], v220 offset:128
    ds_read_b64_tr_b16 v[114:115], v220 offset:4736
    ds_read_b64_tr_b16 v[116:117], v221 offset:128
    ds_read_b64_tr_b16 v[118:119], v221 offset:4736
    ds_read_b64_tr_b16 v[120:121], v222 offset:128
    ds_read_b64_tr_b16 v[122:123], v222 offset:4736
    ds_read_b64_tr_b16 v[124:125], v223 offset:128
    ds_read_b64_tr_b16 v[126:127], v223 offset:4736
    v_mfma_f32_16x16x32_bf16 v[208:211], v[172:175], v[168:171], 0
    s_waitcnt lgkmcnt(14)
    v_mfma_f32_16x16x32_bf16 v[176:179], v[96:99], v[168:171], 0
    s_waitcnt lgkmcnt(12)
    v_mfma_f32_16x16x32_bf16 v[180:183], v[100:103], v[168:171], 0
    s_waitcnt lgkmcnt(10)
    v_mfma_f32_16x16x32_bf16 v[184:187], v[104:107], v[168:171], 0
    s_waitcnt lgkmcnt(8)
    v_mfma_f32_16x16x32_bf16 v[188:191], v[108:111], v[168:171], 0
    ds_write2_b32 v11, v24, v208 offset0:0 offset1:4
    s_waitcnt lgkmcnt(7)
    v_mfma_f32_16x16x32_bf16 v[192:195], v[112:115], v[168:171], 0
    ds_write_b128 v10, v[176:179] offset:20480
    s_waitcnt lgkmcnt(6)
    v_mfma_f32_16x16x32_bf16 v[196:199], v[116:119], v[168:171], 0
    ds_write_b128 v10, v[180:183] offset:20544
    s_waitcnt lgkmcnt(5)
    v_mfma_f32_16x16x32_bf16 v[200:203], v[120:123], v[168:171], 0
    ds_write_b128 v10, v[184:187] offset:20608
    s_waitcnt lgkmcnt(4)
    v_mfma_f32_16x16x32_bf16 v[204:207], v[124:127], v[168:171], 0
    ds_write_b128 v10, v[188:191] offset:20672
    ds_write_b128 v10, v[192:195] offset:20736
    ds_write_b128 v10, v[196:199] offset:20800
    s_nop 1
    ds_write_b128 v10, v[200:203] offset:20864
    s_nop 1
    ds_write_b128 v10, v[204:207] offset:20928
    ds_add_u32 v1, v3 offset:2304
L_spin_22:
    ds_read_b32 v2, v1 offset:2304
    ds_read_b128 v[32:35], v13 offset:4352
    ds_read_b128 v[36:39], v13 offset:4368
    ds_read_b128 v[40:43], v12 offset:20480
    ds_read_b128 v[44:47], v12 offset:29184
    ds_read_b128 v[48:51], v12 offset:37888
    ds_read_b128 v[52:55], v12 offset:46592
    s_waitcnt lgkmcnt(0)
    v_readfirstlane_b32 s64, v2
    s_nop 0
    s_cmp_ge_u32 s64, 4
    s_cbranch_scc1 L_done_23
    s_sub_u32 s60, s60, 1
    s_cbranch_scc0 L_spin_22
    s_endpgm
L_done_23:
    s_cmp_lg_u32 s3, 3
    s_cbranch_scc1 L_noOhint
    s_lshr_b32 s64, s2, 3
    s_add_u32 s64, s64, s16
    s_mov_b64 exec, 0xffff
    buffer_store_byte v31, v251, s[40:43], s64 offen offset:1024
L_noOhint:
    s_mov_b64 exec, -1
    v_max3_f32 v24, v32, v33, v34
    v_max_f32 v24, v24, v35
    v_sub_f32 v32, v32, v24
    v_sub_f32 v33, v33, v24
    v_sub_f32 v34, v34, v24
    v_sub_f32 v35, v35, v24
    v_exp_f32 v32, v32
    v_exp_f32 v33, v33
    v_exp_f32 v34, v34
    v_exp_f32 v35, v35
    v_mul_f32 v25, v32, v36
    v_fmac_f32 v25, v33, v37
    v_fmac_f32 v25, v34, v38
    v_fmac_f32 v25, v35, v39
    v_rcp_f32 v26, v25
    v_pk_mul_f32 v[40:41], v[40:41], v[32:33] op_sel:[0,0] op_sel_hi:[1,0]
    v_pk_mul_f32 v[42:43], v[42:43], v[32:33] op_sel:[0,0] op_sel_hi:[1,0]
    v_pk_fma_f32 v[40:41], v[44:45], v[32:33], v[40:41] op_sel:[0,1,0] op_sel_hi:[1,1,1]
    v_pk_fma_f32 v[42:43], v[46:47], v[32:33], v[42:43] op_sel:[0,1,0] op_sel_hi:[1,1,1]
    v_pk_fma_f32 v[40:41], v[48:49], v[34:35], v[40:41] op_sel:[0,0,0] op_sel_hi:[1,0,1]
    v_pk_fma_f32 v[42:43], v[50:51], v[34:35], v[42:43] op_sel:[0,0,0] op_sel_hi:[1,0,1]
    v_pk_fma_f32 v[40:41], v[52:53], v[34:35], v[40:41] op_sel:[0,1,0] op_sel_hi:[1,1,1]
    v_pk_fma_f32 v[42:43], v[54:55], v[34:35], v[42:43] op_sel:[0,1,0] op_sel_hi:[1,1,1]
    v_pk_mul_f32 v[40:41], v[40:41], v[26:27] op_sel_hi:[1,0]
    v_pk_mul_f32 v[42:43], v[42:43], v[26:27] op_sel_hi:[1,0]
    v_cvt_pk_bf16_f32 v44, v40, v41
    v_cvt_pk_bf16_f32 v45, v42, v43
    v_log_f32 v25, v25
    v_permlane32_swap_b32 v44, v46
    v_permlane32_swap_b32 v45, v47
    s_mov_b32 exec_hi, 0
    s_cmp_eq_u64 s[30:31], 0
    s_cbranch_scc0 L_far_24
    buffer_store_dwordx4 v[44:47], v14, s[40:43], s44 offen
L_back_25:
    v_dot2_u32_u16 v32, v44, v228, 0
    v_dot2_u32_u16 v33, v45, v229, 0
    v_dot2_u32_u16 v34, v46, v230, 0
    v_dot2_u32_u16 v35, v47, v231, 0
    v_add_f32 v30, v24, v25
    v_add_u32 v29, v32, v33
    s_nop 0
    v_add3_u32 v29, v29, v34, v35
    s_nop 1
    v_add_u32_dpp v29, v29, v29 quad_perm:[1,0,3,2] row_mask:0xf bank_mask:0xf
    s_nop 1
    v_add_u32_dpp v29, v29, v29 quad_perm:[2,3,0,1] row_mask:0xf bank_mask:0xf
    s_nop 1
    v_add_u32_dpp v29, v29, v29 row_half_mirror row_mask:0xf bank_mask:0xf
    s_mov_b32 exec_lo, 0x01010101
    s_cmp_eq_u64 s[30:31], 0
    s_cbranch_scc0 L_far_26
    buffer_store_dwordx4 v[28:31], v232, s[40:43], s45 offen
L_back_27:
    s_mov_b64 exec, -1
    v_bfe_u32 v22, v5, 4, 1
    v_lshl_or_b32 v22, v22, 1, v21
    s_cmp_eq_u32 s3, 2
    s_cbranch_scc1 L_B2
    s_cmp_eq_u32 s3, 3
    s_cbranch_scc1 L_B3
    s_xor_b32 s48, s3, s50
    s_lshl_b32 s65, s3, 9
    s_cmp_eq_u32 s68, 1
    s_cselect_b32 s47, 0, s48
    s_cmp_lg_u32 s47, 0
    s_cbranch_scc1 L_recv
    v_lshl_add_u32 v22, v5, 1, s65
    s_lshl_b32 s64, s50, 4
    v_mov_b32 v23, s64
    ds_read_b128 v[32:35], v23 offset:4096
    s_waitcnt lgkmcnt(0)
    v_add_f32 v32, v32, v33
    v_add_f32 v34, v34, v35
    v_add_f32 v32, v32, v34
    v_cvt_pk_bf16_f32 v32, 0, v32
    v_mul_f32 v32, 0xbfb8aa3b, v32
    v_exp_f32 v32, v32
    s_nop 0
    v_add_f32 v32, 1.0, v32
    v_rcp_f32 v32, v32
    s_nop 0
    v_cvt_pk_bf16_f32 v27, 0, v32
    s_lshl_b32 s64, s48, 3
    s_xor_b32 s64, s64, s69
    s_lshl1_add_u32 s64, s64, s50
    s_lshl_b32 s53, s64, 13
    s_add_u32 s53, s53, 2097152
    s_lshl_b32 s54, s64, 10
    s_add_u32 s54, s54, 262656
    s_lshl_b32 s55, s64, 9
    s_add_u32 s55, s55, 393216
    v_lshrrev_b32 v24, 3, v5
    v_and_b32 v25, 7, v5
    v_lshlrev_b32 v20, 4, v25
    v_lshl_or_b32 v20, v24, 10, v20
    v_and_b32 v21, 3, v5
    v_lshl_or_b32 v21, v24, 2, v21
    v_lshlrev_b32 v21, 4, v21
    v_cmp_gt_u32 vcc, 4, v25
    s_nop 1
    v_cndmask_b32 v26, 0, -1, vcc
    s_add_u32 s17, s16, 1024
L_hint_28:
    s_load_dwordx8 s[8:15], s[40:41], s17
    ds_read_b32 v2, v1 offset:1280
    s_add_u32 s17, s17, 64
    s_waitcnt lgkmcnt(0)
    v_readfirstlane_b32 s64, v2
    s_xor_b64 s[8:9], s[8:9], s[18:19]
    s_xor_b64 s[10:11], s[10:11], s[18:19]
    s_xor_b64 s[12:13], s[12:13], s[18:19]
    s_xor_b64 s[14:15], s[14:15], s[18:19]
    s_cmp_ge_u32 s64, 4
    s_cbranch_scc1 L_hdone_29
    s_or_b64 s[8:9], s[8:9], s[10:11]
    s_or_b64 s[12:13], s[12:13], s[14:15]
    s_or_b64 s[8:9], s[8:9], s[12:13]
    s_cbranch_scc0 L_hx_30
    s_and_b32 s64, s17, 1023
    s_cbranch_scc1 L_hint_28
L_spin_31:
    ds_read_b32 v2, v1 offset:1280
    s_waitcnt lgkmcnt(0)
    v_readfirstlane_b32 s64, v2
    s_nop 0
    s_cmp_ge_u32 s64, 4
    s_cbranch_scc1 L_done_32
    s_sub_u32 s60, s60, 1
    s_cbranch_scc0 L_spin_31
    s_endpgm
L_done_32:
L_hx_30:
L_hdone_29:
L_oretry:
    buffer_load_dwordx4 v[80:83], v21, s[40:43], s54 offen sc1 nt
    buffer_load_dwordx4 v[64:67], v20, s[40:43], s53 offen offset:0 sc1 nt
    buffer_load_dwordx4 v[68:71], v20, s[40:43], s53 offen offset:256 sc1 nt
    buffer_load_dwordx4 v[72:75], v20, s[40:43], s53 offen offset:512 sc1 nt
    buffer_load_dwordx4 v[76:79], v20, s[40:43], s53 offen offset:768 sc1 nt
    s_waitcnt vmcnt(4)
    v_mov_b32 v24, v82
    v_and_b32 v81, v81, v26
    v_sub_u32 v32, 0, v81
    v_max_f32_dpp v24, v24, v24 quad_perm:[1,0,3,2] row_mask:0xf bank_mask:0xf
    s_nop 1
    v_max_f32_dpp v24, v24, v24 quad_perm:[2,3,0,1] row_mask:0xf bank_mask:0xf
    s_nop 1
    v_max_f32_dpp v24, v24, v24 row_ror:8 row_mask:0xf bank_mask:0xf
    v_mov_b32 v25, v24
    s_nop 1
    v_permlane16_swap_b32 v24, v25
    v_max_f32 v24, v24, v25
    v_mov_b32 v25, v24
    s_nop 1
    v_permlane32_swap_b32 v24, v25
    v_max_f32 v24, v24, v25
    v_sub_f32 v82, v82, v24
    v_exp_f32 v82, v82
    s_nop 0
    v_mov_b32 v24, v82
    s_nop 1
    v_add_f32_dpp v24, v24, v24 quad_perm:[1,0,3,2] row_mask:0xf bank_mask:0xf
    s_nop 1
    v_add_f32_dpp v24, v24, v24 quad_perm:[2,3,0,1] row_mask:0xf bank_mask:0xf
    s_nop 1
    v_add_f32_dpp v24, v24, v24 row_ror:8 row_mask:0xf bank_mask:0xf
    v_mov_b32 v25, v24
    s_nop 1
    v_permlane16_swap_b32 v24, v25
    v_add_f32 v24, v24, v25
    v_mov_b32 v25, v24
    s_nop 1
    v_permlane32_swap_b32 v24, v25
    v_add_f32 v24, v24, v25
    v_rcp_f32 v24, v24
    s_nop 0
    v_mul_f32 v24, v24, v27
    s_nop 1
    v_mul_f32_dpp v84, v82, v24 quad_perm:[0,0,0,0] row_mask:0xf bank_mask:0xf
    v_mul_f32_dpp v86, v82, v24 quad_perm:[1,1,1,1] row_mask:0xf bank_mask:0xf
    v_mul_f32_dpp v88, v82, v24 quad_perm:[2,2,2,2] row_mask:0xf bank_mask:0xf
    v_mul_f32_dpp v90, v82, v24 quad_perm:[3,3,3,3] row_mask:0xf bank_mask:0xf
    s_waitcnt vmcnt(3)
    v_dot2_u32_u16 v32, v64, v228, v32
    v_dot2_u32_u16 v33, v65, v229, 0
    v_dot2_u32_u16 v34, v66, v230, 0
    v_dot2_u32_u16 v35, v67, v231, 0
    v_lshlrev_b32 v44, 16, v64
    v_and_b32 v45, s49, v64
    v_lshlrev_b32 v46, 16, v65
    v_and_b32 v47, s49, v65
    v_lshlrev_b32 v48, 16, v66
    v_and_b32 v49, s49, v66
    v_lshlrev_b32 v50, 16, v67
    v_and_b32 v51, s49, v67
    v_pk_mul_f32 v[36:37], v[44:45], v[84:85] op_sel_hi:[1,0]
    v_pk_mul_f32 v[38:39], v[46:47], v[84:85] op_sel_hi:[1,0]
    v_pk_mul_f32 v[40:41], v[48:49], v[84:85] op_sel_hi:[1,0]
    v_pk_mul_f32 v[42:43], v[50:51], v[84:85] op_sel_hi:[1,0]
    s_waitcnt vmcnt(2)
    v_dot2_u32_u16 v32, v68, v228, v32
    v_dot2_u32_u16 v33, v69, v229, v33
    v_dot2_u32_u16 v34, v70, v230, v34
    v_dot2_u32_u16 v35, v71, v231, v35
    v_lshlrev_b32 v44, 16, v68
    v_and_b32 v45, s49, v68
    v_lshlrev_b32 v46, 16, v69
    v_and_b32 v47, s49, v69
    v_lshlrev_b32 v48, 16, v70
    v_and_b32 v49, s49, v70
    v_lshlrev_b32 v50, 16, v71
    v_and_b32 v51, s49, v71
    v_pk_fma_f32 v[36:37], v[44:45], v[86:87], v[36:37] op_sel_hi:[1,0,1]
    v_pk_fma_f32 v[38:39], v[46:47], v[86:87], v[38:39] op_sel_hi:[1,0,1]
    v_pk_fma_f32 v[40:41], v[48:49], v[86:87], v[40:41] op_sel_hi:[1,0,1]
    v_pk_fma_f32 v[42:43], v[50:51], v[86:87], v[42:43] op_sel_hi:[1,0,1]
    s_waitcnt vmcnt(1)
    v_dot2_u32_u16 v32, v72, v228, v32
    v_dot2_u32_u16 v33, v73, v229, v33
    v_dot2_u32_u16 v34, v74, v230, v34
    v_dot2_u32_u16 v35, v75, v231, v35
    v_lshlrev_b32 v44, 16, v72
    v_and_b32 v45, s49, v72
    v_lshlrev_b32 v46, 16, v73
    v_and_b32 v47, s49, v73
    v_lshlrev_b32 v48, 16, v74
    v_and_b32 v49, s49, v74
    v_lshlrev_b32 v50, 16, v75
    v_and_b32 v51, s49, v75
    v_pk_fma_f32 v[36:37], v[44:45], v[88:89], v[36:37] op_sel_hi:[1,0,1]
    v_pk_fma_f32 v[38:39], v[46:47], v[88:89], v[38:39] op_sel_hi:[1,0,1]
    v_pk_fma_f32 v[40:41], v[48:49], v[88:89], v[40:41] op_sel_hi:[1,0,1]
    v_pk_fma_f32 v[42:43], v[50:51], v[88:89], v[42:43] op_sel_hi:[1,0,1]
    s_waitcnt vmcnt(0)
    v_dot2_u32_u16 v32, v76, v228, v32
    v_dot2_u32_u16 v33, v77, v229, v33
    v_dot2_u32_u16 v34, v78, v230, v34
    v_dot2_u32_u16 v35, v79, v231, v35
    v_lshlrev_b32 v44, 16, v76
    v_and_b32 v45, s49, v76
    v_lshlrev_b32 v46, 16, v77
    v_and_b32 v47, s49, v77
    v_lshlrev_b32 v48, 16, v78
    v_and_b32 v49, s49, v78
    v_lshlrev_b32 v50, 16, v79
    v_and_b32 v51, s49, v79
    v_add_u32 v2, v32, v33
    v_add3_u32 v2, v2, v34, v35
    v_pk_fma_f32 v[36:37], v[44:45], v[90:91], v[36:37] op_sel_hi:[1,0,1]
    v_pk_fma_f32 v[38:39], v[46:47], v[90:91], v[38:39] op_sel_hi:[1,0,1]
    v_add_u32_dpp v2, v2, v2 quad_perm:[1,0,3,2] row_mask:0xf bank_mask:0xf
    v_pk_fma_f32 v[40:41], v[48:49], v[90:91], v[40:41] op_sel_hi:[1,0,1]
    v_pk_fma_f32 v[42:43], v[50:51], v[90:91], v[42:43] op_sel_hi:[1,0,1]
    v_add_u32_dpp v2, v2, v2 quad_perm:[2,3,0,1] row_mask:0xf bank_mask:0xf
    v_permlane32_swap_b32 v36, v40
    v_permlane32_swap_b32 v37, v41
    v_add_u32_dpp v2, v2, v2 row_half_mirror row_mask:0xf bank_mask:0xf
    v_permlane32_swap_b32 v38, v42
    v_permlane32_swap_b32 v39, v43
    v_pk_add_f32 v[36:37], v[36:37], v[40:41]
    v_pk_add_f32 v[38:39], v[38:39], v[42:43]
    v_bitop3_b32 v2, v83, s61, v2 bitop3:0xbe
    v_cmp_ne_u32 vcc, 0, v2
    v_permlane16_swap_b32 v36, v38
    v_permlane16_swap_b32 v37, v39
    v_pk_add_f32 v[36:37], v[36:37], v[38:39]
    s_cbranch_vccz L_ok_33
    s_sub_u32 s60, s60, 8
    s_cbranch_scc0 L_oretry
    s_endpgm
L_ok_33:
    s_nop 0
    v_add_f32_dpp v34, v36, v36 row_ror:8 row_mask:0xf bank_mask:0x3
    s_nop 1
    v_add_f32_dpp v34, v37, v37 row_ror:8 row_mask:0xf bank_mask:0xc
    v_cvt_pk_bf16_f32 v32, 0, v34
    s_cmp_lg_u32 s48, 0
    s_cbranch_scc1 L_send
L_ofrag:
    ds_write_b16_d16_hi v22, v32 offset:4608
    ds_add_u32 v1, v3 offset:2560
    s_endpgm
L_send:
    v_mov_b32 v33, v32
    s_nop 1
    v_permlane16_swap_b32 v32, v33
    s_nop 1
    v_permlane32_swap_b32 v32, v34
    v_permlane32_swap_b32 v33, v35
    v_or_b32 v32, v32, v224
    v_or_b32 v33, v33, v225
    v_or_b32 v34, v34, v226
    v_or_b32 v35, v35, v227
    s_mov_b64 exec, 0xffff
    buffer_store_dwordx4 v[32:35], v7, s[40:43], s55 offen sc1
    s_lshr_b32 s64, s2, 3
    s_add_u32 s64, s64, s16
    s_mov_b64 exec, 0xffff
    buffer_store_byte v31, v251, s[40:43], s64 offen offset:3072
    s_mov_b64 exec, -1
L_recv:
    s_lshl1_add_u32 s55, s69, s3
    s_lshl_b32 s55, s55, 9
    s_add_u32 s55, s55, 393216
    v_and_b32 v24, 3, v5
    v_lshrrev_b32 v22, 2, v5
    v_lshl_or_b32 v22, v24, 4, v22
    s_lshl_b32 s65, s3, 9
    v_lshl_add_u32 v22, v22, 1, s65
    v_lshlrev_b32 v24, 3, v24
    v_bfe_u32 v24, v31, v24, 8
    s_lshl2_add_u32 s64, s63, 1
    s_lshl_b32 s26, 1, s64
    s_bitreplicate_b64_b32 s[26:27], s26
    s_bitreplicate_b64_b32 s[24:25], s26
    s_bitreplicate_b64_b32 s[26:27], s27
    s_bitreplicate_b64_b32 s[20:21], s24
    s_bitreplicate_b64_b32 s[22:23], s25
    s_bitreplicate_b64_b32 s[24:25], s26
    s_bitreplicate_b64_b32 s[26:27], s27
    s_add_u32 s17, s16, 1024
L_hint_34:
    s_load_dwordx8 s[8:15], s[40:41], s17
    ds_read_b32 v2, v1 offset:1280
    s_add_u32 s17, s17, 64
    s_waitcnt lgkmcnt(0)
    v_readfirstlane_b32 s64, v2
    s_xor_b64 s[8:9], s[8:9], s[18:19]
    s_xor_b64 s[10:11], s[10:11], s[18:19]
    s_xor_b64 s[12:13], s[12:13], s[18:19]
    s_xor_b64 s[14:15], s[14:15], s[18:19]
    s_cmp_ge_u32 s64, 4
    s_cbranch_scc1 L_hdone_35
    s_or_b64 s[8:9], s[8:9], s[10:11]
    s_or_b64 s[12:13], s[12:13], s[14:15]
    s_or_b64 s[8:9], s[8:9], s[12:13]
    s_cbranch_scc0 L_hx_36
    s_and_b32 s64, s17, 1023
    s_cbranch_scc1 L_hint_34
L_spin_37:
    ds_read_b32 v2, v1 offset:1280
    s_waitcnt lgkmcnt(0)
    v_readfirstlane_b32 s64, v2
    s_nop 0
    s_cmp_ge_u32 s64, 4
    s_cbranch_scc1 L_done_38
    s_sub_u32 s60, s60, 1
    s_cbranch_scc0 L_spin_37
    s_endpgm
L_done_38:
L_hx_36:
L_hdone_35:
    s_add_u32 s17, s16, 3072
L_hint_39:
    s_load_dwordx8 s[8:15], s[40:41], s17
    ds_read_b32 v2, v1 offset:3584
    s_add_u32 s17, s17, 64
    s_waitcnt lgkmcnt(0)
    v_readfirstlane_b32 s64, v2
    s_xor_b64 s[8:9], s[8:9], s[18:19]
    s_xor_b64 s[10:11], s[10:11], s[18:19]
    s_xor_b64 s[12:13], s[12:13], s[18:19]
    s_xor_b64 s[14:15], s[14:15], s[18:19]
    s_cmp_ge_u32 s64, 4
    s_cbranch_scc1 L_hdone_40
    s_and_b64 s[8:9], s[8:9], s[20:21]
    s_and_b64 s[10:11], s[10:11], s[22:23]
    s_and_b64 s[12:13], s[12:13], s[24:25]
    s_and_b64 s[14:15], s[14:15], s[26:27]
    s_or_b64 s[8:9], s[8:9], s[10:11]
    s_or_b64 s[12:13], s[12:13], s[14:15]
    s_or_b64 s[8:9], s[8:9], s[12:13]
    s_cbranch_scc0 L_hx_41
    s_and_b32 s64, s17, 1023
    s_cbranch_scc1 L_hint_39
L_spin_42:
    ds_read_b32 v2, v1 offset:3584
    s_waitcnt lgkmcnt(0)
    v_readfirstlane_b32 s64, v2
    s_nop 0
    s_cmp_ge_u32 s64, 4
    s_cbranch_scc1 L_done_43
    s_sub_u32 s60, s60, 1
    s_cbranch_scc0 L_spin_42
    s_endpgm
L_done_43:
L_hx_41:
L_hdone_40:
L_rretry:
    buffer_load_dword v32, v1, s[40:43], s55 offen sc1
    s_waitcnt vmcnt(0)
    v_cmp_ne_u32_sdwa vcc, v32, v24 src0_sel:WORD_0 src1_sel:DWORD
    s_cbranch_vccz L_ok_44
    s_sub_u32 s60, s60, 8
    s_cbranch_scc0 L_rretry
    s_endpgm
L_ok_44:
    s_branch L_ofrag
L_B2:
    v_and_b32 v23, 16, v5
    ds_read_b128 v[32:35], v23 offset:4096
    s_waitcnt lgkmcnt(0)
    v_add_f32 v32, v32, v33
    v_add_f32 v34, v34, v35
    v_add_f32 v32, v32, v34
    v_cvt_pk_bf16_f32 v32, 0, v32
    v_mul_f32 v32, 0xbfb8aa3b, v32
    v_exp_f32 v32, v32
    s_nop 0
    v_add_f32 v32, 1.0, v32
    v_rcp_f32 v32, v32
    s_nop 0
    v_cvt_pk_bf16_f32 v27, 0, v32
    v_sub_f32 v27, 1.0, v27
    v_cvt_pk_bf16_f32 v27, 0, v27
    s_mul_i32 s65, s63, 14
    s_lshl_b32 s53, s67, 17
    s_add_u32 s53, s53, 4194304
    s_add_u32 s54, s53, 7168
    v_min_u32 v25, 13, v19
    v_add_u32 v26, s65, v25
    v_mul_u32_u24 v24, 17920, v18
    v_lshl_add_u32 v24, v26, 4, v24
    s_sub_u32 s66, 4, s67
    s_and_b32 s66, s66, 7
    v_lshrrev_b32 v26, 4, v26
    v_lshl_add_u32 v24, v26, 8, v24
    v_add_u32 v26, s66, v26
    v_subrev_u32 v2, 7, v26
    v_min_u32 v26, v26, v2
    s_mov_b32 s26, 0
    v_readlane_b32 s8, v26, 0
    s_nop 0
    s_lshl_b32 s9, 0x1000, s8
    s_and_b32 s8, s8, 3
    s_lshl_b32 s8, s8, 2
    s_lshl_b32 s8, 15, s8
    s_or_b32 s26, s26, s8
    s_or_b32 s26, s26, s9
    v_readlane_b32 s8, v26, 13
    s_nop 0
    s_lshl_b32 s9, 0x1000, s8
    s_and_b32 s8, s8, 3
    s_lshl_b32 s8, s8, 2
    s_lshl_b32 s8, 15, s8
    s_or_b32 s26, s26, s8
    s_or_b32 s26, s26, s9
    s_pack_ll_b32_b16 s26, s26, s26
    s_lshr_b32 s8, s2, 3
    s_bitset0_b32 s26, s8
    s_bitreplicate_b64_b32 s[26:27], s26
    s_bitreplicate_b64_b32 s[24:25], s26
    s_bitreplicate_b64_b32 s[26:27], s27
    s_bitreplicate_b64_b32 s[20:21], s24
    s_bitreplicate_b64_b32 s[22:23], s25
    s_bitreplicate_b64_b32 s[24:25], s26
    s_bitreplicate_b64_b32 s[26:27], s27
    v_cmp_gt_u32 vcc, 4, v26
    s_nop 1
    v_cndmask_b32 v26, 0, -1, vcc
    v_and_b32 v20, 14336, v26
    v_add_u32 v20, v20, v24
    v_and_b32 v28, 1.0, v26
    v_lshl_add_u32 v25, v25, 2, v21
    v_lshlrev_b32 v23, 5, v23
    v_and_b32 v2, 7, v25
    v_lshl_add_u32 v23, v2, 4, v23
    v_lshrrev_b32 v2, 3, v25
    v_lshl_add_u32 v23, v2, 1, v23
L_spin_48:
    ds_read_b32 v2, v1 offset:3840
    s_waitcnt lgkmcnt(0)
    v_readfirstlane_b32 s64, v2
    s_nop 0
    s_cmp_ge_u32 s64, 1
    s_cbranch_scc1 L_done_49
    s_sub_u32 s60, s60, 1
    s_cbranch_scc0 L_spin_48
    s_endpgm
L_done_49:
    s_add_u32 s17, s16, 2048
L_hint_45:
    s_load_dwordx8 s[8:15], s[40:41], s17
    ds_read_b32 v2, v1 offset:1536
    s_add_u32 s17, s17, 64
    s_waitcnt lgkmcnt(0)
    v_readfirstlane_b32 s64, v2
    s_xor_b64 s[8:9], s[8:9], s[18:19]
    s_xor_b64 s[10:11], s[10:11], s[18:19]
    s_xor_b64 s[12:13], s[12:13], s[18:19]
    s_xor_b64 s[14:15], s[14:15], s[18:19]
    s_cmp_ge_u32 s64, 4
    s_cbranch_scc1 L_hdone_46
    s_and_b64 s[8:9], s[8:9], s[20:21]
    s_and_b64 s[10:11], s[10:11], s[22:23]
    s_and_b64 s[12:13], s[12:13], s[24:25]
    s_and_b64 s[14:15], s[14:15], s[26:27]
    s_or_b64 s[8:9], s[8:9], s[10:11]
    s_or_b64 s[12:13], s[12:13], s[14:15]
    s_or_b64 s[8:9], s[8:9], s[12:13]
    s_cbranch_scc0 L_hx_47
    s_and_b32 s64, s17, 1023
    s_cbranch_scc1 L_hint_45
L_spin_50:
    ds_read_b32 v2, v1 offset:1536
    s_waitcnt lgkmcnt(0)
    v_readfirstlane_b32 s64, v2
    s_nop 0
    s_cmp_ge_u32 s64, 4
    s_cbranch_scc1 L_done_51
    s_sub_u32 s60, s60, 1
    s_cbranch_scc0 L_spin_50
    s_endpgm
L_done_51:
L_hx_47:
L_hdone_46:
L_gretry:
    buffer_load_dwordx4 v[64:67], v24, s[40:43], s53 offen offset:0 sc1 nt
    buffer_load_dwordx4 v[68:71], v24, s[40:43], s53 offen offset:3584 sc1 nt
    buffer_load_dwordx4 v[72:75], v24, s[40:43], s54 offen offset:0 sc1 nt
    buffer_load_dwordx4 v[76:79], v24, s[40:43], s54 offen offset:3584 sc1 nt
    buffer_load_dwordx4 v[80:83], v20, s[40:43], s53 offen sc1 nt
    s_waitcnt vmcnt(4)
    v_xor_b32 v64, s56, v64
    v_xor_b32 v65, s57, v65
    v_xor_b32 v66, s58, v66
    v_xor_b32 v67, s59, v67
    v_or3_b32 v2, v64, v65, 0
    v_or3_b32 v2, v66, v67, v2
    s_waitcnt vmcnt(3)
    v_xor_b32 v68, s56, v68
    v_xor_b32 v69, s57, v69
    v_xor_b32 v70, s58, v70
    v_xor_b32 v71, s59, v71
    v_or3_b32 v2, v68, v69, v2
    v_or3_b32 v2, v70, v71, v2
    v_pk_add_f32 v[64:65], v[64:65], v[68:69]
    v_pk_add_f32 v[66:67], v[66:67], v[70:71]
    s_waitcnt vmcnt(2)
    v_xor_b32 v72, s56, v72
    v_xor_b32 v73, s57, v73
    v_xor_b32 v74, s58, v74
    v_xor_b32 v75, s59, v75
    v_or3_b32 v2, v72, v73, v2
    v_or3_b32 v2, v74, v75, v2
    v_pk_add_f32 v[64:65], v[64:65], v[72:73]
    v_pk_add_f32 v[66:67], v[66:67], v[74:75]
    s_waitcnt vmcnt(1)
    v_xor_b32 v76, s56, v76
    v_xor_b32 v77, s57, v77
    v_xor_b32 v78, s58, v78
    v_xor_b32 v79, s59, v79
    v_or3_b32 v2, v76, v77, v2
    v_or3_b32 v2, v78, v79, v2
    v_pk_add_f32 v[64:65], v[64:65], v[76:77]
    v_pk_add_f32 v[66:67], v[66:67], v[78:79]
    s_waitcnt vmcnt(0)
    v_xor_b32 v80, s56, v80
    v_xor_b32 v81, s57, v81
    v_xor_b32 v82, s58, v82
    v_xor_b32 v83, s59, v83
    v_or3_b32 v2, v80, v81, v2
    v_or3_b32 v2, v82, v83, v2
    v_cmp_ne_u32_sdwa vcc, v2, v250 src0_sel:BYTE_0 src1_sel:DWORD
    v_pk_fma_f32 v[64:65], v[80:81], v[28:29], v[64:65] op_sel_hi:[1,0,1]
    v_pk_fma_f32 v[66:67], v[82:83], v[28:29], v[66:67] op_sel_hi:[1,0,1]
    s_cbranch_vccz L_ok_52
    s_sub_u32 s60, s60, 8
    s_cbranch_scc0 L_gretry
    s_endpgm
L_ok_52:
    v_permlane32_swap_b32 v64, v65
    v_permlane32_swap_b32 v66, v67
    v_mul_f32 v64, 0xbfb8aa3b, v64
    v_mul_f32 v66, 0xbfb8aa3b, v66
    v_exp_f32 v64, v64
    v_exp_f32 v66, v66
    v_mul_f32 v65, v27, v65
    v_mul_f32 v67, v27, v67
    v_add_f32 v64, 1.0, v64
    v_add_f32 v66, 1.0, v66
    v_rcp_f32 v64, v64
    v_rcp_f32 v66, v66
    v_mul_f32 v64, v64, v65
    v_mul_f32 v66, v66, v67
    v_cvt_pk_bf16_f32 v64, v64, v66
    ds_write_b16 v23, v64 offset:4736
    ds_write_b16_d16_hi v23, v64 offset:4768
    ds_add_u32 v1, v3 offset:2816
    s_endpgm
L_B3:
    s_and_b32 s46, s63, 3
    s_add_u32 s64, s67, 3
    s_and_b32 s64, s64, 7
    s_add_u32 s48, s46, s64
    s_add_u32 s47, s46, 4
    s_cmp_eq_u32 s46, 3
    s_cselect_b32 s47, s68, s47
    s_add_u32 s47, s47, s64
    s_sub_u32 s64, s47, 7
    s_min_u32 s47, s47, s64
    s_sub_u32 s64, s48, 7
    s_min_u32 s48, s48, s64
    s_cmp_eq_u32 s46, 3
    s_cselect_b32 s65, 4, s68
    s_mul_i32 s65, s65, 7
    s_add_u32 s47, s47, s65
    s_mul_i32 s65, s68, 7
    s_add_u32 s48, s48, s65
    s_cmp_lt_u32 s63, 4
    s_cselect_b32 s65, 0, 70
    s_cselect_b32 s66, 70, 0
    s_add_u32 s47, s47, s65
    s_add_u32 s48, s48, s66
    v_mov_b32 v24, s47
    v_mov_b32 v25, s48
    v_cmp_gt_u32 vcc, 32, v5
    s_nop 1
    v_cndmask_b32 v24, v25, v24, vcc
    v_and_b32 v25, 1, v18
    v_mad_u32_u24 v24, v25, 35, v24
    v_lshl_add_u32 v24, v24, 5, v19
    v_lshlrev_b32 v24, 4, v24
    s_lshl_b32 s44, s67, 17
    s_add_u32 s44, s44, 4194304
L_spin_53:
    ds_read_b32 v2, v1 offset:1024
    s_waitcnt lgkmcnt(0)
    v_readfirstlane_b32 s64, v2
    s_nop 0
    s_cmp_ge_u32 s64, 4
    s_cbranch_scc1 L_done_54
    s_sub_u32 s60, s60, 1
    s_cbranch_scc0 L_spin_53
    s_endpgm
L_done_54:
    ds_read_b128 v[32:35], v7 offset:8704
    ds_read_b128 v[36:39], v7 offset:10240
    ds_read_b128 v[40:43], v7 offset:11776
    ds_read_b128 v[44:47], v7 offset:13312
    ds_read_b128 v[48:51], v7 offset:14848
    ds_read_b128 v[52:55], v7 offset:16384
    ds_read_b128 v[56:59], v7 offset:17920
    ds_read_b128 v[60:63], v7 offset:19456
    s_waitcnt lgkmcnt(0)
    v_pk_add_f32 v[32:33], v[32:33], v[48:49]
    v_pk_add_f32 v[34:35], v[34:35], v[50:51]
    v_pk_add_f32 v[36:37], v[36:37], v[52:53]
    v_pk_add_f32 v[38:39], v[38:39], v[54:55]
    v_pk_add_f32 v[40:41], v[40:41], v[56:57]
    v_pk_add_f32 v[42:43], v[42:43], v[58:59]
    v_pk_add_f32 v[44:45], v[44:45], v[60:61]
    v_pk_add_f32 v[46:47], v[46:47], v[62:63]
    v_pk_add_f32 v[32:33], v[32:33], v[40:41]
    v_pk_add_f32 v[34:35], v[34:35], v[42:43]
    v_pk_add_f32 v[36:37], v[36:37], v[44:45]
    v_pk_add_f32 v[38:39], v[38:39], v[46:47]
    v_pk_add_f32 v[32:33], v[32:33], v[36:37]
    v_pk_add_f32 v[34:35], v[34:35], v[38:39]
    v_and_or_b32 v32, v32, s62, v224
    v_and_or_b32 v33, v33, s62, v225
    v_and_or_b32 v34, v34, s62, v226
    v_and_or_b32 v35, v35, s62, v227
    s_cmp_eq_u64 s[30:31], 0
    s_cbranch_scc0 L_far_55
    buffer_store_dwordx4 v[32:35], v24, s[40:43], s44 offen
L_back_56:
    s_lshr_b32 s64, s2, 3
    s_add_u32 s64, s64, s16
    s_mov_b64 exec, 0xffff
    buffer_store_byte v31, v251, s[40:43], s64 offen offset:2048
    s_mov_b64 exec, -1
    ds_add_u32 v1, v3 offset:3840
    s_lshr_b32 s65, s2, 3
    s_lshl_b32 s66, s67, 5
    s_add_u32 s65, s65, s66
    s_lshr_b32 s53, s65, 2
    s_lshl_b32 s53, s53, 14
    s_and_b32 s66, s65, 3
    s_lshl_b32 s66, s66, 5
    s_add_u32 s53, s53, s66
    s_add_u32 s53, s53, 1048576
    v_lshrrev_b32 v25, 1, v5
    v_and_b32 v26, 1, v5
    v_lshl_or_b32 v25, v25, 4, v26
    v_lshlrev_b32 v25, 4, v25
    s_add_u32 s54, s53, 8192
    s_andn2_b32 s55, s65, 7
    s_lshl4_add_u32 s55, s55, s66
    s_and_b32 s66, s65, 4
    s_lshl1_add_u32 s55, s66, s55
    v_lshlrev_b32 v22, 1, v22
    v_lshl_add_u32 v23, v19, 4, v22
L_spin_57:
    ds_read_b32 v2, v1 offset:1792
    s_waitcnt lgkmcnt(0)
    v_readfirstlane_b32 s64, v2
    s_nop 0
    s_cmp_ge_u32 s64, 4
    s_cbranch_scc1 L_done_58
    s_sub_u32 s60, s60, 1
    s_cbranch_scc0 L_spin_57
    s_endpgm
L_done_58:
    s_lshl_b32 s48, s67, 12
    s_add_u32 s48, s48, 590336
    v_lshlrev_b32 v26, 3, v5
    s_movk_i32 s65, 16
L_hint:
    buffer_load_dwordx2 v[28:29], v26, s[40:43], s48 offen sc1
    s_sub_u32 s65, s65, 1
    s_cbranch_scc1 L_hintend
    s_waitcnt vmcnt(0)
    v_xor_b32 v28, s61, v28
    v_bitop3_b32 v28, v29, s61, v28 bitop3:0xbe
    v_cmp_ne_u32 vcc, 0, v28
    s_cbranch_vccnz L_hint
L_hintend:
L_fretry:
    buffer_load_dwordx4 v[64:67], v25, s[40:43], s53 offen offset:0 sc1
    buffer_load_dwordx4 v[68:71], v25, s[40:43], s54 offen offset:0 sc1
    s_waitcnt vmcnt(1)
    v_xor_b32 v64, s56, v64
    v_xor_b32 v65, s57, v65
    v_xor_b32 v66, s58, v66
    v_xor_b32 v67, s59, v67
    v_or3_b32 v2, v64, v65, 0
    v_or3_b32 v2, v66, v67, v2
    s_waitcnt vmcnt(0)
    v_xor_b32 v68, s56, v68
    v_xor_b32 v69, s57, v69
    v_xor_b32 v70, s58, v70
    v_xor_b32 v71, s59, v71
    v_or3_b32 v2, v68, v69, v2
    v_or3_b32 v2, v70, v71, v2
    v_cmp_ne_u32_sdwa vcc, v2, v250 src0_sel:BYTE_0 src1_sel:DWORD
    v_pk_add_f32 v[64:65], v[64:65], v[68:69]
    v_pk_add_f32 v[66:67], v[66:67], v[70:71]
    s_cbranch_vccz L_ok_59
    s_sub_u32 s60, s60, 8
    s_cbranch_scc0 L_fretry
    s_endpgm
L_ok_59:
    v_permlane32_swap_b32 v64, v65
    v_permlane32_swap_b32 v66, v67
    v_add_f32 v64, v64, v65
    v_add_f32 v66, v66, v67
    s_nop 1
    v_permlane16_swap_b32 v64, v66
    v_add_f32 v64, v64, v66
    s_nop 1
    v_add_f32_dpp v64, v64, v64 row_ror:2 row_mask:0xf bank_mask:0xf
    s_nop 1
    v_add_f32_dpp v64, v64, v64 row_ror:4 row_mask:0xf bank_mask:0xf
    s_nop 1
    v_add_f32_dpp v64, v64, v64 row_ror:8 row_mask:0xf bank_mask:0xf
    v_cvt_pk_bf16_f32 v64, v64, v64
    s_mov_b32 exec_lo, 0x30003
    s_mov_b32 exec_hi, 0x30003
    buffer_store_short v64, v23, s[36:39], s55 offen
    s_cmp_lg_u32 s2, 0
    s_cbranch_scc1 L_fin
    s_mov_b64 exec, 1
    s_mov_b32 s66, 524288
    buffer_store_dword v31, v1, s[40:43], s66 offen
L_fin:
    s_endpgm
L_far_7:
    buffer_store_dwordx4 v[32:35], v232, s[40:43], s49 offen sc1
    s_branch L_back_8
L_far_24:
    buffer_store_dwordx4 v[44:47], v14, s[40:43], s44 offen sc1
    s_branch L_back_25
L_far_26:
    buffer_store_dwordx4 v[28:31], v232, s[40:43], s45 offen sc1
    s_branch L_back_27
L_far_55:
    buffer_store_dwordx4 v[32:35], v24, s[40:43], s44 offen sc1
    s_branch L_back_56
L_qretry:
    buffer_load_dword v252, v253, s[40:43], s29 offen sc1
    buffer_load_dwordx4 v[128:131], v233, s[40:43], s53 offen sc1
    buffer_load_dwordx4 v[132:135], v233, s[40:43], s54 offen sc1
    buffer_load_dwordx4 v[136:139], v233, s[40:43], s55 offen sc1
    buffer_load_dwordx4 v[140:143], v233, s[40:43], s48 offen sc1
    s_sub_u32 s60, s60, 8
    s_cbranch_scc0 L_qcheck
L_exit:
    s_endpgm
.if (. - gated_mix__sliding_block_cached__glu_gated_glu__decode_kernel) < 11264
.fill (11264 - (. - gated_mix__sliding_block_cached__glu_gated_glu__decode_kernel))/4, 4, 0xbf810000
.endif

.section .rodata,"a"
.p2align 6
.amdhsa_kernel gated_mix__sliding_block_cached__glu_gated_glu__decode_kernel
  .amdhsa_next_free_vgpr 256
  .amdhsa_next_free_sgpr 102
  .amdhsa_accum_offset 256
  .amdhsa_group_segment_fixed_size 0
  .amdhsa_kernarg_size 104
  .amdhsa_user_sgpr_count 2
  .amdhsa_user_sgpr_kernarg_segment_ptr 1
  .amdhsa_system_sgpr_workgroup_id_x 1
  .amdhsa_float_denorm_mode_32 3
.end_amdhsa_kernel
```
